```python
import torch

def _softmax(x, axis=-1):
    return torch.softmax(x, dim=axis)
def _gelu(x):
    return torch.nn.functional.gelu(x, approximate="tanh")
def _silu(x):
    return torch.nn.functional.silu(x)
def _sigmoid(x):
    return torch.sigmoid(x)
def _layernorm(x, axis=-1, eps=1e-5):
    m = x.mean(dim=axis, keepdim=True)
    v = x.var(dim=axis, keepdim=True, unbiased=False)
    return (x - m) / torch.sqrt(v + eps)
def _scatter_add(tgt, idx, src, axis=0):
    return tgt.clone().index_add_(axis, idx, src)
def _segment_sum(src, seg, n):
    out = torch.zeros((n,) + src.shape[1:], dtype=src.dtype)
    return out.index_add_(0, seg, src)
def _pad(x, pw):
    flat = tuple(v for pair in reversed(pw) for v in pair)
    return torch.nn.functional.pad(x, flat)

kernel_name = 'standalone__weight_only_int_gptq__prompt'

def setup_inputs():

    _w = (lambda a: (lambda t: t.to(torch.bfloat16) if t.is_floating_point() else t)(torch.as_tensor(a)))
    B, S, D, F = 1, 2048, 1024, 3584
    bits = max(2, min(4, 3))
    pf = 32 // bits
    G = 64 if 64 > 0 else D
    G = max(pf, (G // pf) * pf)
    D = max(G, (D // G) * G)
    ng = D // G
    qmax = 1 << bits
    qw = torch.randint(0, qmax, (D, F)).to(torch.int64)
    packed = torch.zeros((D // pf, F), dtype=torch.int64)
    for i in range(pf):
        packed |= (qw[i::pf] << (i * bits))
    packed = packed.to(torch.int32)
    return {
        "x": _w((lambda *s: torch.randn(*s, dtype=torch.bfloat16) * 0.05)(B, S, D)),
        "qw_packed": _w(packed),
        "scales": _w(torch.abs((lambda *s: torch.randn(*s, dtype=torch.bfloat16) * 0.05)(ng, F)).to(float) * 0.1 + 0.01),
        "zeros": _w(torch.randint(0, qmax, (ng, F)).to(float)),
        "bits": _w((lambda _x: torch.as_tensor(_x, dtype=torch.int32))(bits)),
    }

def reference(x, qw_packed, scales, zeros, bits):
    b = int(bits)
    pf = 32 // b
    mask = (1 << b) - 1
    P, F = qw_packed.shape
    D = P * pf
    ng = scales.shape[0]
    G = D // ng
    shifts = (lambda x, dt: x.to(dt))(torch.arange(pf) * b, qw_packed.dtype)
    qw = ((qw_packed[:, None, :] >> shifts[None, :, None]) & mask).reshape(D, F)
    s = (lambda x, n, axis: torch.repeat_interleave(x, n, dim=axis))(scales, G, axis=0)
    z = (lambda x, n, axis: torch.repeat_interleave(x, n, dim=axis))(zeros, G, axis=0)
    w = ((lambda x, dt: x.to(dt))(qw, x.dtype) - z) * s
    return torch.einsum("bsd,df->bsf", x, w)
```

```asm
; @launch grid=(256,1,1) block=(512,1,1) lds=163840
.amdgcn_target "amdgcn-amd-amdhsa--gfx950"
.text
.globl standalone__weight_only_int_gptq__prompt_kernel
.p2align 12
.p2align 8
.type standalone__weight_only_int_gptq__prompt_kernel,@function
standalone__weight_only_int_gptq__prompt_kernel:
  s_load_dwordx2 s[16:17], s[0:1], 16
  s_load_dwordx2 s[20:21], s[0:1], 24
  s_load_dwordx2 s[12:13], s[0:1], 8
  s_load_dwordx2 s[8:9], s[0:1], 0
  s_load_dwordx2 s[24:25], s[0:1], 40
  v_lshrrev_b32_e64 v1, 6, v0
  s_cmp_lt_u32 s2, 256
  s_cbranch_scc1 L_go
L_exit:
  s_endpgm
L_go:
  v_readfirstlane_b32 s36, v1
  s_getpc_b64 s[58:59]
L_pc:
  s_bfe_u32 s37, s2, 0x40003
  s_lshl_b32 s37, s37, 11
  v_and_b32 v38, 63, v0
  v_min_u32 v38, 3, v38
  v_lshl_add_u32 v38, v1, 2, v38
  v_lshl_add_u32 v38, v38, 6, s37
  v_min_u32 v38, L_codeend-L_pc-4, v38
  v_mov_b32 v45, s59
  v_add_co_u32 v44, vcc, s58, v38
  s_nop 1
  v_addc_co_u32 v45, vcc, 0, v45, vcc
  global_load_dword v30, v[44:45], off
  s_and_b32 s37, s2, 7
  s_lshr_b32 s38, s2, 3
  s_bfe_u32 s39, s2, 0x10001
  s_and_b32 s40, s2, 1
  s_lshl_b32 s40, s40, 1
  s_or_b32 s39, s39, s40
  s_and_b32 s37, s2, 4
  s_or_b32 s37, s37, s39
  s_lshr_b32 s39, s37, 1
  s_and_b32 s40, s39, 1
  s_add_u32 s40, s40, s38
  s_cmp_ge_u32 s40, 32
  s_cbranch_scc1 L_exit
  s_mul_i32 s39, s39, 63
  s_add_u32 s39, s39, 1
  s_lshr_b32 s39, s39, 1
  s_add_u32 s38, s38, s39
  s_mul_i32 s39, s38, 4682
  s_lshr_b32 s39, s39, 16
  s_mul_i32 s40, s39, 14
  s_sub_u32 s6, s38, s40
  s_and_b32 s37, s37, 1
  s_mul_i32 s37, s37, 14
  s_add_u32 s38, s6, s37
  s_lshl_b32 s30, s38, 9
  s_lshl_b32 s31, s38, 8
  s_mov_b32 s32, s39
  s_lshr_b32 s35, s36, 2
  s_and_b32 s29, s36, 3
  v_and_b32 v32, 63, v0
  v_and_b32 v33, 15, v0
  v_bfe_u32 v34, v0, 4, 2
  s_mov_b32 s14, 1462272
  s_mov_b32 s15, 0x20000
  s_mov_b32 s18, 121856
  s_mov_b32 s19, 0x20000
  s_mov_b32 s22, 121856
  s_mov_b32 s23, 0x20000
  s_lshl_b32 s37, s35, 2
  s_lshl_b32 s38, s29, 7
  s_lshl_b32 s39, s29, 6
  s_lshl_b32 s40, s35, 3
  s_lshl_b32 s3, s36, 10
  s_add_u32 s3, s3, 99328
  s_mul_i32 s33, s36, 1920
  s_add_u32 s33, s33, 148480
  v_add_u32 v36, s37, v34
  v_mul_u32_u24 v38, 12, v36
  v_bfe_u32 v39, v0, 3, 1
  v_add_u32 v38, v38, v39
  v_mul_u32_u24 v38, 14336, v38
  v_and_b32_e64 v39, 7, v32
  v_lshl_add_u32 v243, v39, 4, s38
  v_add_u32_e64 v5, v38, v243
  v_bfe_u32 v38, v0, 2, 3
  v_add_u32 v38, s40, v38
  v_and_b32 v39, 32, v0
  v_add_u32 v38, v38, v39
  v_min_u32 v38, 16, v38
  v_mul_u32_u24 v38, 7168, v38
  v_and_b32_e64 v39, 3, v32
  v_lshl_add_u32 v38, v39, 4, v38
  v_add_u32 v46, s39, v38
  s_waitcnt lgkmcnt(0)
  s_mov_b32 exec_hi, 0xf
  s_add_u32 m0, s33, 768
  s_nop 0
  buffer_load_dwordx4 v46, s[16:19], s31 offen  lds
  s_add_u32 m0, s33, 1344
  s_nop 0
  buffer_load_dwordx4 v46, s[20:23], s31 offen  lds
  s_mov_b32 exec_hi, -1
  s_add_u32 m0, s3, 0
  s_add_u32 s38, s30, 0
  buffer_load_dwordx4 v5, s[12:15], s38 offen  lds
  s_mul_i32 s28, s32, 14
  s_cmp_gt_u32 s32, 0
  s_addc_u32 s28, s28, 0
  s_cmp_gt_u32 s32, 5
  s_addc_u32 s28, s28, 0
  s_cmp_eq_u32 s32, 0
  s_cselect_b32 s34, 1, 0
  s_cmp_eq_u32 s32, 5
  s_cselect_b32 s34, 1, s34
  s_mul_i32 s7, s28, 32640
  s_mov_b32 s10, 4177920
  s_mov_b32 s11, 0x20000
  v_lshrrev_b32 v38, 3, v32
  v_mul_u32_u24 v39, 14336, v38
  v_add_u32_e64 v243, v243, v39
  v_lshl_add_u32 v38, v32, 2, s29
  v_mul_u32_u24 v38, 14, v38
  v_add_u32 v38, s6, v38
  v_cmp_gt_u32 vcc, 1021, v38
  v_lshlrev_b32_e64 v38, 7, v38
  v_mov_b32 v39, 0x7fff0000
  v_cndmask_b32 v9, v39, v38, vcc
  s_cmp_eq_u32 s35, 0
  s_cbranch_scc1 L_p1
  s_barrier
  s_add_u32 s38, s7, 0
  buffer_load_dwordx2 v[30:31], v9, s[8:11], s38 offen offset:60
L_p1:
  s_add_u32 m0, s3, 8192
  s_add_u32 s38, s30, 28672
  buffer_load_dwordx4 v5, s[12:15], s38 offen  lds
  s_add_u32 m0, s3, 16384
  s_add_u32 s38, s30, 57344
  buffer_load_dwordx4 v5, s[12:15], s38 offen  lds
  s_add_u32 m0, s3, 24576
  s_add_u32 s38, s30, 86016
  buffer_load_dwordx4 v5, s[12:15], s38 offen  lds
  s_mov_b32 m0, s33
  s_add_u32 s38, s30, 1376256
  s_mov_b32 exec_hi, 0xffff
  buffer_load_dwordx4 v243, s[12:15], s38 offen  lds
  s_mov_b32 exec_hi, -1
  s_add_u32 m0, s3, 32768
  s_add_u32 s38, s30, 114688
  buffer_load_dwordx4 v5, s[12:15], s38 offen  lds
  s_add_u32 m0, s3, 40960
  s_add_u32 s38, s30, 143360
  buffer_load_dwordx4 v5, s[12:15], s38 offen  lds
  s_cmp_eq_u32 s35, 1
  s_cbranch_scc1 L_p2
  s_barrier
  s_setprio 2
L_p2:
  s_mov_b32 s26, 14680064
  s_mov_b32 s27, 0x20000
  s_mul_i32 s32, s28, 114688
  s_add_u32 s32, s32, s31
  s_lshl_b32 s39, s29, 6
  s_lshl_b32 s28, s28, 2
  s_add_u32 s28, s28, s29
  s_mul_i32 s28, s28, 8160
  s_mul_i32 s29, s29, 8256
  s_mul_i32 s1, s35, 0xffff0000
  v_and_b32 v38, 3, v0
  v_lshlrev_b32_e64 v37, 5, v38
  v_bfe_u32 v38, v0, 2, 2
  v_lshl_add_u32 v37, v38, 3, v37
  v_lshl_add_u32 v6, v34, 8, v37
  v_add_u32 v6, s3, v6
  v_lshrrev_b32 v39, 1, v37
  s_add_u32 s37, s33, 768
  v_add_u32_e64 v244, s37, v39
  v_lshl_add_u32 v242, v34, 7, v244
  v_add_u32 v244, 512, v244
  v_mul_u32_u24 v38, 240, v34
  v_lshl_add_u32 v38, v33, 4, v38
  v_lshlrev_b32_e64 v39, 4, v34
  v_add_u32 v39, 1920, v39
  v_cmp_gt_u32 vcc, 15, v33
  v_subrev_u32 v41, 896, v39
  v_min_u32 v41, 1064, v41
  v_cndmask_b32 v3, v39, v38, vcc
  v_cndmask_b32 v4, v41, v38, vcc
  s_sub_u32 s96, s8, 64
  s_subb_u32 s97, s9, 0
  s_mov_b32 s98, 4177984
  s_mov_b32 s99, 0x20000
  v_mul_u32_u24 v38, 2064, v33
  v_lshl_add_u32 v1, v36, 8, v38
  v_add_u32 v2, 66048, v1
  v_lshlrev_b32 v40, 2, v36
  v_min_u32 v40, 26, v40
  v_add_u32 v38, 0, v40
  v_mul_u32_u24 v39, 205, v38
  v_lshrrev_b32_e64 v39, 10, v39
  v_lshl_add_u32 v80, v39, 7, v37
  v_add_u32 v80, s33, v80
  v_mul_u32_u24 v39, 5, v39
  v_sub_u32 v38, v38, v39
  v_mul_u32_u24 v76, 6, v38
  v_add_u32_e64 v38, 1, v40
  v_mul_u32_u24 v39, 205, v38
  v_lshrrev_b32_e64 v39, 10, v39
  v_lshl_add_u32 v81, v39, 7, v37
  v_add_u32 v81, s33, v81
  v_mul_u32_u24 v39, 5, v39
  v_sub_u32 v38, v38, v39
  v_mul_u32_u24 v77, 6, v38
  v_add_u32_e64 v38, 2, v40
  v_mul_u32_u24 v39, 205, v38
  v_lshrrev_b32_e64 v39, 10, v39
  v_lshl_add_u32 v82, v39, 7, v37
  v_add_u32 v82, s33, v82
  v_mul_u32_u24 v39, 5, v39
  v_sub_u32 v38, v38, v39
  v_mul_u32_u24 v78, 6, v38
  v_add_u32_e64 v38, 3, v40
  v_mul_u32_u24 v39, 205, v38
  v_lshrrev_b32_e64 v39, 10, v39
  v_lshl_add_u32 v83, v39, 7, v37
  v_add_u32 v83, s33, v83
  v_mul_u32_u24 v39, 5, v39
  v_sub_u32 v38, v38, v39
  v_mul_u32_u24 v79, 6, v38
  v_and_b32 v38, 0xff, v0
  v_lshlrev_b32_e64 v7, 4, v38
  v_add_u32 v7, 132096, v7
  v_lshrrev_b32_e64 v38, 2, v32
  v_mul_u32_u24 v38, 7168, v38
  v_and_b32_e64 v39, 3, v32
  v_lshl_add_u32 v38, v39, 4, v38
  v_add_u32_e64 v8, s39, v38
  s_mov_b32 s41, 0x7070707
  s_mov_b32 s42, 0x30000
  s_mov_b32 s43, 0x50002
  s_mov_b32 s44, 0x6020400
  s_mov_b32 s45, 0x7030501
  s_mov_b32 s46, 0x60704
  s_mov_b32 s47, 0xc0c0501
  s_mov_b32 s48, 0x6040200
  s_mov_b32 s49, 0x7050301
  s_mov_b32 s50, 0xc0c0400
  s_mov_b32 s51, 0xffff0000
  s_mov_b64 vcc, 0
  s_lshr_b32 s37, s29, 1
  v_lshl_add_u32 v5, v32, 4, s37
  s_waitcnt vmcnt(7)
  s_nop 0
  ds_read2_b32 v[240:241], v242 offset0:0 offset1:144
  ds_read2_b32 v[84:85], v242 offset0:16 offset1:160
  ds_read2_b32 v[86:87], v244 offset0:0 offset1:144
  s_waitcnt vmcnt(6)
  s_nop 0
  ds_read_b64 v[10:11], v6 offset:0
  ds_read_b64 v[12:13], v6 offset:128
  s_waitcnt lgkmcnt(4)
  v_lshlrev_b32 v216, 16, v240
  v_and_b32 v226, s51, v240
  v_lshlrev_b32 v217, 16, v241
  v_and_b32_e64 v227, s51, v241
  v_mul_f32_e64 v208, -v217, v216
  v_mul_f32_e64 v218, -v227, v226
  v_add_f32 v209, v216, v208
  v_add_f32 v219, v226, v218
  v_fma_f32 v210, v216, 2.0, v208
  v_fma_f32 v220, v226, 2.0, v218
  v_fmamk_f32 v211, v216, 0x40400000, v208
  v_fmamk_f32 v221, v226, 0x40400000, v218
  v_fma_f32 v212, v216, 4.0, v208
  v_fma_f32 v222, v226, 4.0, v218
  v_fmamk_f32 v213, v216, 0x40a00000, v208
  v_fmamk_f32 v223, v226, 0x40a00000, v218
  v_fmamk_f32 v214, v216, 0x40c00000, v208
  v_fmamk_f32 v224, v226, 0x40c00000, v218
  v_fmamk_f32 v215, v216, 0x40e00000, v208
  v_fmamk_f32 v225, v226, 0x40e00000, v218
  v_cvt_pk_bf16_f32 v209, v208, v209
  v_cvt_pk_bf16_f32 v219, v218, v219
  v_cvt_pk_bf16_f32 v211, v210, v211
  v_cvt_pk_bf16_f32 v221, v220, v221
  v_cvt_pk_bf16_f32 v213, v212, v213
  v_cvt_pk_bf16_f32 v223, v222, v223
  v_cvt_pk_bf16_f32 v215, v214, v215
  v_cvt_pk_bf16_f32 v225, v224, v225
  v_perm_b32 v22, v211, v209, s48
  v_perm_b32 v26, v221, v219, s48
  v_perm_b32 v23, v215, v213, s48
  v_perm_b32 v27, v225, v223, s48
  v_perm_b32 v24, v211, v209, s49
  v_perm_b32 v28, v221, v219, s49
  v_perm_b32 v25, v215, v213, s49
  v_perm_b32 v29, v225, v223, s49
  s_waitcnt lgkmcnt(0)
  s_nop 0
  v_lshrrev_b64 v[56:57], 4, v[10:11]
  v_lshrrev_b64 v[58:59], 4, v[12:13]
  v_perm_b32 v10, v10, v56, s46
  v_perm_b32 v11, v11, v57, s46
  v_perm_b32 v12, v12, v58, s46
  v_perm_b32 v13, v13, v59, s46
  v_perm_b32 v56, v58, v56, s47
  v_perm_b32 v57, v59, v57, s47
  v_pk_lshrrev_b16 v60, s42, v10 op_sel:[0,0] op_sel_hi:[1,0]
  v_pk_lshrrev_b16 v62, s42, v11 op_sel:[0,0] op_sel_hi:[1,0]
  v_and_b32 v60, s41, v60
  v_and_b32 v62, s41, v62
  v_perm_b32 v61, v23, v22, v60
  v_perm_b32 v63, v27, v26, v62
  v_perm_b32 v60, v25, v24, v60
  v_perm_b32 v62, v29, v28, v62
  v_perm_b32 v128, v60, v61, s44
  v_perm_b32 v132, v62, v63, s44
  v_perm_b32 v136, v60, v61, s45
  v_perm_b32 v140, v62, v63, s45
  v_pk_lshrrev_b16 v60, s43, v10 op_sel:[0,1] op_sel_hi:[1,1]
  v_pk_lshrrev_b16 v62, s43, v11 op_sel:[0,1] op_sel_hi:[1,1]
  v_and_b32 v60, s41, v60
  v_and_b32 v62, s41, v62
  v_perm_b32 v61, v23, v22, v60
  v_perm_b32 v63, v27, v26, v62
  v_perm_b32 v60, v25, v24, v60
  v_perm_b32 v62, v29, v28, v62
  v_perm_b32 v131, v60, v61, s44
  v_perm_b32 v135, v62, v63, s44
  v_perm_b32 v129, v60, v61, s45
  v_perm_b32 v133, v62, v63, s45
  v_pk_lshrrev_b16 v60, s42, v56 op_sel:[0,0] op_sel_hi:[1,0]
  v_pk_lshrrev_b16 v62, s42, v57 op_sel:[0,0] op_sel_hi:[1,0]
  v_and_b32 v60, s41, v60
  v_and_b32 v62, s41, v62
  v_perm_b32 v61, v23, v22, v60
  v_perm_b32 v63, v27, v26, v62
  v_perm_b32 v60, v25, v24, v60
  v_perm_b32 v62, v29, v28, v62
  v_perm_b32 v130, v60, v61, s44
  v_perm_b32 v134, v62, v63, s44
  v_perm_b32 v139, v60, v61, s45
  v_perm_b32 v143, v62, v63, s45
  v_pk_lshrrev_b16 v60, s42, v12 op_sel:[0,0] op_sel_hi:[1,0]
  v_pk_lshrrev_b16 v62, s42, v13 op_sel:[0,0] op_sel_hi:[1,0]
  v_and_b32 v60, s41, v60
  v_and_b32 v62, s41, v62
  v_perm_b32 v61, v23, v22, v60
  v_perm_b32 v63, v27, v26, v62
  v_perm_b32 v60, v25, v24, v60
  v_perm_b32 v62, v29, v28, v62
  v_perm_b32 v137, v60, v61, s44
  v_perm_b32 v141, v62, v63, s44
  v_perm_b32 v145, v60, v61, s45
  v_perm_b32 v149, v62, v63, s45
  s_waitcnt vmcnt(5)
  s_nop 0
  ds_read_b64 v[14:15], v6 offset:8192
  ds_read_b64 v[16:17], v6 offset:8320
  v_pk_lshrrev_b16 v60, s43, v12 op_sel:[0,1] op_sel_hi:[1,1]
  v_pk_lshrrev_b16 v62, s43, v13 op_sel:[0,1] op_sel_hi:[1,1]
  v_and_b32 v60, s41, v60
  v_and_b32 v62, s41, v62
  v_perm_b32 v61, v23, v22, v60
  v_perm_b32 v63, v27, v26, v62
  v_perm_b32 v60, v25, v24, v60
  v_perm_b32 v62, v29, v28, v62
  v_perm_b32 v144, v60, v61, s44
  v_perm_b32 v148, v62, v63, s44
  v_perm_b32 v138, v60, v61, s45
  v_perm_b32 v142, v62, v63, s45
  s_waitcnt lgkmcnt(0)
  s_nop 0
  v_lshrrev_b64 v[56:57], 4, v[14:15]
  v_lshrrev_b64 v[58:59], 4, v[16:17]
  v_perm_b32 v14, v14, v56, s46
  v_perm_b32 v15, v15, v57, s46
  v_perm_b32 v16, v16, v58, s46
  v_perm_b32 v17, v17, v59, s46
  v_perm_b32 v56, v58, v56, s47
  v_perm_b32 v57, v59, v57, s47
  v_pk_lshrrev_b16 v60, s42, v14 op_sel:[0,0] op_sel_hi:[1,0]
  v_pk_lshrrev_b16 v62, s42, v15 op_sel:[0,0] op_sel_hi:[1,0]
  v_and_b32 v60, s41, v60
  v_and_b32 v62, s41, v62
  v_perm_b32 v61, v23, v22, v60
  v_perm_b32 v63, v27, v26, v62
  v_perm_b32 v60, v25, v24, v60
  v_perm_b32 v62, v29, v28, v62
  v_perm_b32 v146, v60, v61, s44
  v_perm_b32 v150, v62, v63, s44
  v_perm_b32 v154, v60, v61, s45
  v_perm_b32 v158, v62, v63, s45
  v_pk_lshrrev_b16 v60, s43, v14 op_sel:[0,1] op_sel_hi:[1,1]
  v_pk_lshrrev_b16 v62, s43, v15 op_sel:[0,1] op_sel_hi:[1,1]
  v_and_b32 v60, s41, v60
  v_and_b32 v62, s41, v62
  v_perm_b32 v61, v23, v22, v60
  v_perm_b32 v63, v27, v26, v62
  v_perm_b32 v60, v25, v24, v60
  v_perm_b32 v62, v29, v28, v62
  v_perm_b32 v153, v60, v61, s44
  v_perm_b32 v157, v62, v63, s44
  v_perm_b32 v147, v60, v61, s45
  v_perm_b32 v151, v62, v63, s45
  v_pk_lshrrev_b16 v60, s42, v56 op_sel:[0,0] op_sel_hi:[1,0]
  v_pk_lshrrev_b16 v62, s42, v57 op_sel:[0,0] op_sel_hi:[1,0]
  v_and_b32 v60, s41, v60
  v_and_b32 v62, s41, v62
  v_perm_b32 v61, v23, v22, v60
  v_perm_b32 v63, v27, v26, v62
  v_perm_b32 v60, v25, v24, v60
  v_perm_b32 v62, v29, v28, v62
  v_perm_b32 v152, v60, v61, s44
  v_perm_b32 v156, v62, v63, s44
  v_perm_b32 v161, v60, v61, s45
  v_perm_b32 v165, v62, v63, s45
  v_pk_lshrrev_b16 v60, s42, v16 op_sel:[0,0] op_sel_hi:[1,0]
  v_pk_lshrrev_b16 v62, s42, v17 op_sel:[0,0] op_sel_hi:[1,0]
  v_and_b32 v60, s41, v60
  v_and_b32 v62, s41, v62
  v_perm_b32 v61, v23, v22, v60
  v_perm_b32 v63, v27, v26, v62
  v_perm_b32 v60, v25, v24, v60
  v_perm_b32 v62, v29, v28, v62
  v_perm_b32 v155, v60, v61, s44
  v_perm_b32 v159, v62, v63, s44
  v_perm_b32 v163, v60, v61, s45
  v_perm_b32 v167, v62, v63, s45
  s_waitcnt vmcnt(4)
  s_nop 0
  ds_read_b64 v[18:19], v6 offset:16384
  ds_read_b64 v[20:21], v6 offset:16512
  v_pk_lshrrev_b16 v60, s43, v16 op_sel:[0,1] op_sel_hi:[1,1]
  v_pk_lshrrev_b16 v62, s43, v17 op_sel:[0,1] op_sel_hi:[1,1]
  v_and_b32 v60, s41, v60
  v_and_b32 v62, s41, v62
  v_perm_b32 v61, v23, v22, v60
  v_perm_b32 v63, v27, v26, v62
  v_perm_b32 v60, v25, v24, v60
  v_perm_b32 v62, v29, v28, v62
  v_perm_b32 v162, v60, v61, s44
  v_perm_b32 v166, v62, v63, s44
  v_perm_b32 v160, v60, v61, s45
  v_perm_b32 v164, v62, v63, s45
  s_waitcnt lgkmcnt(0)
  s_nop 0
  v_lshrrev_b64 v[56:57], 4, v[18:19]
  v_lshrrev_b64 v[58:59], 4, v[20:21]
  v_perm_b32 v18, v18, v56, s46
  v_perm_b32 v19, v19, v57, s46
  v_perm_b32 v20, v20, v58, s46
  v_perm_b32 v21, v21, v59, s46
  v_perm_b32 v56, v58, v56, s47
  v_perm_b32 v57, v59, v57, s47
  v_pk_lshrrev_b16 v60, s42, v18 op_sel:[0,0] op_sel_hi:[1,0]
  v_pk_lshrrev_b16 v62, s42, v19 op_sel:[0,0] op_sel_hi:[1,0]
  v_and_b32 v60, s41, v60
  v_and_b32 v62, s41, v62
  v_perm_b32 v61, v23, v22, v60
  v_perm_b32 v63, v27, v26, v62
  v_perm_b32 v60, v25, v24, v60
  v_perm_b32 v62, v29, v28, v62
  v_perm_b32 v168, v60, v61, s44
  v_perm_b32 v172, v62, v63, s44
  s_waitcnt vmcnt(3)
  s_nop 0
  ds_read_b64 v[64:65], v6 offset:24576
  ds_read_b64 v[66:67], v6 offset:24704
  v_perm_b32 v176, v60, v61, s45
  v_perm_b32 v180, v62, v63, s45
  v_pk_lshrrev_b16 v60, s43, v18 op_sel:[0,1] op_sel_hi:[1,1]
  v_pk_lshrrev_b16 v62, s43, v19 op_sel:[0,1] op_sel_hi:[1,1]
  v_and_b32 v60, s41, v60
  v_and_b32 v62, s41, v62
  v_perm_b32 v61, v23, v22, v60
  v_perm_b32 v63, v27, v26, v62
  v_perm_b32 v60, v25, v24, v60
  v_perm_b32 v62, v29, v28, v62
  v_perm_b32 v171, v60, v61, s44
  v_perm_b32 v175, v62, v63, s44
  v_perm_b32 v169, v60, v61, s45
  v_perm_b32 v173, v62, v63, s45
  v_pk_lshrrev_b16 v60, s42, v56 op_sel:[0,0] op_sel_hi:[1,0]
  v_pk_lshrrev_b16 v62, s42, v57 op_sel:[0,0] op_sel_hi:[1,0]
  v_and_b32 v60, s41, v60
  v_and_b32 v62, s41, v62
  v_perm_b32 v61, v23, v22, v60
  v_perm_b32 v63, v27, v26, v62
  v_perm_b32 v60, v25, v24, v60
  v_perm_b32 v62, v29, v28, v62
  v_perm_b32 v170, v60, v61, s44
  v_perm_b32 v174, v62, v63, s44
  v_perm_b32 v179, v60, v61, s45
  v_perm_b32 v183, v62, v63, s45
  v_pk_lshrrev_b16 v60, s42, v20 op_sel:[0,0] op_sel_hi:[1,0]
  v_pk_lshrrev_b16 v62, s42, v21 op_sel:[0,0] op_sel_hi:[1,0]
  v_and_b32 v60, s41, v60
  v_and_b32 v62, s41, v62
  v_perm_b32 v61, v23, v22, v60
  v_perm_b32 v63, v27, v26, v62
  v_perm_b32 v60, v25, v24, v60
  v_perm_b32 v62, v29, v28, v62
  v_perm_b32 v177, v60, v61, s44
  v_perm_b32 v181, v62, v63, s44
  v_perm_b32 v185, v60, v61, s45
  v_perm_b32 v189, v62, v63, s45
  v_pk_lshrrev_b16 v60, s43, v20 op_sel:[0,1] op_sel_hi:[1,1]
  v_pk_lshrrev_b16 v62, s43, v21 op_sel:[0,1] op_sel_hi:[1,1]
  v_and_b32 v60, s41, v60
  v_and_b32 v62, s41, v62
  v_perm_b32 v61, v23, v22, v60
  v_perm_b32 v63, v27, v26, v62
  v_perm_b32 v60, v25, v24, v60
  v_perm_b32 v62, v29, v28, v62
  v_perm_b32 v184, v60, v61, s44
  v_perm_b32 v188, v62, v63, s44
  v_perm_b32 v178, v60, v61, s45
  v_perm_b32 v182, v62, v63, s45
  v_lshlrev_b32 v216, 16, v86
  v_and_b32 v226, s51, v86
  v_lshlrev_b32 v217, 16, v87
  v_and_b32 v227, s51, v87
  v_mul_f32_e64 v208, -v217, v216
  v_mul_f32_e64 v218, -v227, v226
  v_add_f32 v209, v216, v208
  v_add_f32 v219, v226, v218
  v_fma_f32 v210, v216, 2.0, v208
  v_fma_f32 v220, v226, 2.0, v218
  s_waitcnt lgkmcnt(0)
  s_cmp_eq_u32 s35, 0
  s_cbranch_scc1 L_vb0
  s_waitcnt vmcnt(63)
  s_barrier
L_vb0:
  v_fmamk_f32 v211, v216, 0x40400000, v208
  v_fmamk_f32 v221, v226, 0x40400000, v218
  v_fma_f32 v212, v216, 4.0, v208
  v_fma_f32 v222, v226, 4.0, v218
  v_fmamk_f32 v213, v216, 0x40a00000, v208
  v_fmamk_f32 v223, v226, 0x40a00000, v218
  v_fmamk_f32 v214, v216, 0x40c00000, v208
  v_fmamk_f32 v224, v226, 0x40c00000, v218
  v_fmamk_f32 v215, v216, 0x40e00000, v208
  v_fmamk_f32 v225, v226, 0x40e00000, v218
  v_cvt_pk_bf16_f32 v209, v208, v209
  v_cvt_pk_bf16_f32 v219, v218, v219
  s_waitcnt vmcnt(2)
  ds_read_b64 v[10:11], v80
  ds_read_b64 v[12:13], v81
  ds_read_b64 v[14:15], v82
  ds_read_b64 v[16:17], v83
  v_cvt_pk_bf16_f32 v211, v210, v211
  v_cvt_pk_bf16_f32 v221, v220, v221
  v_cvt_pk_bf16_f32 v213, v212, v213
  v_cvt_pk_bf16_f32 v223, v222, v223
  v_cvt_pk_bf16_f32 v215, v214, v215
  v_cvt_pk_bf16_f32 v225, v224, v225
  v_perm_b32 v22, v211, v209, s48
  v_perm_b32 v26, v221, v219, s48
  v_perm_b32 v23, v215, v213, s48
  v_perm_b32 v27, v225, v223, s48
  v_perm_b32 v24, v211, v209, s49
  v_perm_b32 v28, v221, v219, s49
  v_perm_b32 v25, v215, v213, s49
  v_perm_b32 v29, v225, v223, s49
  s_waitcnt lgkmcnt(0)
  s_nop 0
  v_lshrrev_b64 v[10:11], v76, v[10:11]
  v_lshrrev_b64 v[12:13], v77, v[12:13]
  v_lshrrev_b64 v[14:15], v78, v[14:15]
  v_lshrrev_b64 v[16:17], v79, v[16:17]
  v_perm_b32 v10, v12, v10, s50
  v_perm_b32 v11, v13, v11, s50
  v_pk_lshrrev_b16 v60, s42, v10 op_sel:[0,0] op_sel_hi:[1,0]
  v_pk_lshrrev_b16 v62, s42, v11 op_sel:[0,0] op_sel_hi:[1,0]
  v_and_b32 v60, s41, v60
  v_and_b32 v62, s41, v62
  v_perm_b32 v61, v23, v22, v60
  v_perm_b32 v63, v27, v26, v62
  v_perm_b32 v60, v25, v24, v60
  v_perm_b32 v62, v29, v28, v62
  v_perm_b32 v248, v60, v61, s44
  v_perm_b32 v252, v62, v63, s44
  v_perm_b32 v249, v60, v61, s45
  v_perm_b32 v253, v62, v63, s45
  v_perm_b32 v14, v16, v14, s50
  v_perm_b32 v15, v17, v15, s50
  v_pk_lshrrev_b16 v60, s42, v14 op_sel:[0,0] op_sel_hi:[1,0]
  v_pk_lshrrev_b16 v62, s42, v15 op_sel:[0,0] op_sel_hi:[1,0]
  v_and_b32 v60, s41, v60
  v_and_b32 v62, s41, v62
  v_perm_b32 v61, v23, v22, v60
  v_perm_b32 v63, v27, v26, v62
  v_perm_b32 v60, v25, v24, v60
  v_perm_b32 v62, v29, v28, v62
  v_perm_b32 v250, v60, v61, s44
  v_perm_b32 v254, v62, v63, s44
  v_perm_b32 v251, v60, v61, s45
  v_perm_b32 v255, v62, v63, s45
  s_mov_b32 exec_lo, 0
  s_mov_b32 exec_hi, s1
  v_mov_b32 v248, 0
  v_mov_b32 v249, 0
  v_mov_b32 v252, 0
  v_mov_b32 v253, 0
  s_mov_b64 exec, -1
  v_lshlrev_b32 v216, 16, v84
  v_and_b32 v226, s51, v84
  v_lshlrev_b32 v217, 16, v85
  v_and_b32_e64 v227, s51, v85
  v_mul_f32_e64 v208, -v217, v216
  v_mul_f32_e64 v218, -v227, v226
  v_add_f32 v209, v216, v208
  v_add_f32 v219, v226, v218
  v_fma_f32 v210, v216, 2.0, v208
  v_fma_f32 v220, v226, 2.0, v218
  v_fmamk_f32 v211, v216, 0x40400000, v208
  v_fmamk_f32 v221, v226, 0x40400000, v218
  v_fma_f32 v212, v216, 4.0, v208
  v_fma_f32 v222, v226, 4.0, v218
  v_fmamk_f32 v213, v216, 0x40a00000, v208
  v_fmamk_f32 v223, v226, 0x40a00000, v218
  v_fmamk_f32 v214, v216, 0x40c00000, v208
  v_fmamk_f32 v224, v226, 0x40c00000, v218
  v_fmamk_f32 v215, v216, 0x40e00000, v208
  v_fmamk_f32 v225, v226, 0x40e00000, v218
  v_cvt_pk_bf16_f32 v209, v208, v209
  v_cvt_pk_bf16_f32 v219, v218, v219
  v_cvt_pk_bf16_f32 v211, v210, v211
  v_cvt_pk_bf16_f32 v221, v220, v221
  v_cvt_pk_bf16_f32 v213, v212, v213
  v_cvt_pk_bf16_f32 v223, v222, v223
  v_cvt_pk_bf16_f32 v215, v214, v215
  v_cvt_pk_bf16_f32 v225, v224, v225
  v_perm_b32 v22, v211, v209, s48
  v_perm_b32 v26, v221, v219, s48
  v_perm_b32 v23, v215, v213, s48
  v_perm_b32 v27, v225, v223, s48
  v_perm_b32 v24, v211, v209, s49
  v_perm_b32 v28, v221, v219, s49
  v_perm_b32 v25, v215, v213, s49
  v_perm_b32 v29, v225, v223, s49
  v_lshrrev_b64 v[56:57], 4, v[64:65]
  v_lshrrev_b64 v[58:59], 4, v[66:67]
  v_perm_b32 v64, v64, v56, s46
  v_perm_b32 v65, v65, v57, s46
  v_perm_b32 v66, v66, v58, s46
  v_perm_b32 v67, v67, v59, s46
  s_waitcnt vmcnt(1)
  s_nop 0
  ds_read_b64 v[68:69], v6 offset:32768
  ds_read_b64 v[70:71], v6 offset:32896
  s_waitcnt vmcnt(0)
  s_nop 0
  ds_read_b64 v[72:73], v6 offset:40960
  ds_read_b64 v[74:75], v6 offset:41088
  v_perm_b32 v56, v58, v56, s47
  v_perm_b32 v57, v59, v57, s47
  v_pk_lshrrev_b16 v60, s42, v64 op_sel:[0,0] op_sel_hi:[1,0]
  v_pk_lshrrev_b16 v62, s42, v65 op_sel:[0,0] op_sel_hi:[1,0]
  v_and_b32 v60, s41, v60
  v_and_b32 v62, s41, v62
  v_perm_b32 v61, v23, v22, v60
  v_perm_b32 v63, v27, v26, v62
  v_perm_b32 v60, v25, v24, v60
  v_perm_b32 v62, v29, v28, v62
  v_perm_b32 v186, v60, v61, s44
  v_perm_b32 v190, v62, v63, s44
  v_perm_b32 v194, v60, v61, s45
  v_perm_b32 v198, v62, v63, s45
  v_pk_lshrrev_b16 v60, s43, v64 op_sel:[0,1] op_sel_hi:[1,1]
  v_pk_lshrrev_b16 v62, s43, v65 op_sel:[0,1] op_sel_hi:[1,1]
  v_and_b32 v60, s41, v60
  v_and_b32 v62, s41, v62
  v_perm_b32 v61, v23, v22, v60
  v_perm_b32 v63, v27, v26, v62
  v_perm_b32 v60, v25, v24, v60
  v_perm_b32 v62, v29, v28, v62
  v_perm_b32 v193, v60, v61, s44
  v_perm_b32 v197, v62, v63, s44
  v_perm_b32 v187, v60, v61, s45
  v_perm_b32 v191, v62, v63, s45
  v_pk_lshrrev_b16 v60, s42, v56 op_sel:[0,0] op_sel_hi:[1,0]
  v_pk_lshrrev_b16 v62, s42, v57 op_sel:[0,0] op_sel_hi:[1,0]
  v_and_b32 v60, s41, v60
  v_and_b32 v62, s41, v62
  v_perm_b32 v61, v23, v22, v60
  v_perm_b32 v63, v27, v26, v62
  v_perm_b32 v60, v25, v24, v60
  v_perm_b32 v62, v29, v28, v62
  v_perm_b32 v192, v60, v61, s44
  v_perm_b32 v196, v62, v63, s44
  v_perm_b32 v201, v60, v61, s45
  v_perm_b32 v205, v62, v63, s45
  v_pk_lshrrev_b16 v60, s42, v66 op_sel:[0,0] op_sel_hi:[1,0]
  v_pk_lshrrev_b16 v62, s42, v67 op_sel:[0,0] op_sel_hi:[1,0]
  v_and_b32 v60, s41, v60
  v_and_b32 v62, s41, v62
  v_perm_b32 v61, v23, v22, v60
  v_perm_b32 v63, v27, v26, v62
  v_perm_b32 v60, v25, v24, v60
  v_perm_b32 v62, v29, v28, v62
  v_perm_b32 v195, v60, v61, s44
  v_perm_b32 v199, v62, v63, s44
  v_perm_b32 v203, v60, v61, s45
  v_perm_b32 v207, v62, v63, s45
  v_pk_lshrrev_b16 v60, s43, v66 op_sel:[0,1] op_sel_hi:[1,1]
  v_pk_lshrrev_b16 v62, s43, v67 op_sel:[0,1] op_sel_hi:[1,1]
  v_and_b32 v60, s41, v60
  v_and_b32 v62, s41, v62
  v_perm_b32 v61, v23, v22, v60
  v_perm_b32 v63, v27, v26, v62
  v_perm_b32 v60, v25, v24, v60
  v_perm_b32 v62, v29, v28, v62
  v_perm_b32 v202, v60, v61, s44
  v_perm_b32 v206, v62, v63, s44
  s_waitcnt lgkmcnt(0)
  s_cmp_eq_u32 s35, 0
  s_cbranch_scc1 L_vb1
  s_waitcnt vmcnt(63)
  s_barrier
L_vb1:
  v_perm_b32 v200, v60, v61, s45
  v_perm_b32 v204, v62, v63, s45
  v_lshrrev_b64 v[56:57], 4, v[68:69]
  v_lshrrev_b64 v[58:59], 4, v[70:71]
  v_perm_b32 v68, v68, v56, s46
  v_perm_b32 v69, v69, v57, s46
  v_perm_b32 v70, v70, v58, s46
  v_perm_b32 v71, v71, v59, s46
  v_perm_b32 v56, v58, v56, s47
  v_perm_b32 v57, v59, v57, s47
  v_pk_lshrrev_b16 v60, s42, v68 op_sel:[0,0] op_sel_hi:[1,0]
  v_pk_lshrrev_b16 v62, s42, v69 op_sel:[0,0] op_sel_hi:[1,0]
  v_and_b32 v60, s41, v60
  v_and_b32_e64 v62, s41, v62
  v_perm_b32 v61, v23, v22, v60
  v_perm_b32 v63, v27, v26, v62
  v_perm_b32 v60, v25, v24, v60
  v_perm_b32 v62, v29, v28, v62
  v_perm_b32 v208, v60, v61, s44
  v_perm_b32 v212, v62, v63, s44
  v_perm_b32 v216, v60, v61, s45
  v_perm_b32 v220, v62, v63, s45
  v_pk_lshrrev_b16 v60, s43, v68 op_sel:[0,1] op_sel_hi:[1,1]
  v_pk_lshrrev_b16 v62, s43, v69 op_sel:[0,1] op_sel_hi:[1,1]
  v_and_b32 v60, s41, v60
  v_and_b32 v62, s41, v62
  v_perm_b32 v61, v23, v22, v60
  v_perm_b32 v63, v27, v26, v62
  v_perm_b32 v60, v25, v24, v60
  v_perm_b32 v62, v29, v28, v62
  v_perm_b32 v211, v60, v61, s44
  v_perm_b32 v215, v62, v63, s44
  v_perm_b32 v209, v60, v61, s45
  v_perm_b32 v213, v62, v63, s45
  v_pk_lshrrev_b16 v60, s42, v56 op_sel:[0,0] op_sel_hi:[1,0]
  v_pk_lshrrev_b16 v62, s42, v57 op_sel:[0,0] op_sel_hi:[1,0]
  v_and_b32 v60, s41, v60
  v_and_b32 v62, s41, v62
  v_perm_b32 v61, v23, v22, v60
  v_perm_b32 v63, v27, v26, v62
  v_perm_b32 v60, v25, v24, v60
  v_perm_b32 v62, v29, v28, v62
  v_perm_b32 v210, v60, v61, s44
  v_perm_b32 v214, v62, v63, s44
  v_perm_b32 v219, v60, v61, s45
  v_perm_b32 v223, v62, v63, s45
  v_pk_lshrrev_b16 v60, s42, v70 op_sel:[0,0] op_sel_hi:[1,0]
  v_pk_lshrrev_b16 v62, s42, v71 op_sel:[0,0] op_sel_hi:[1,0]
  v_and_b32 v60, s41, v60
  v_and_b32 v62, s41, v62
  v_perm_b32 v61, v23, v22, v60
  v_perm_b32 v63, v27, v26, v62
  v_perm_b32 v60, v25, v24, v60
  v_perm_b32 v62, v29, v28, v62
  v_perm_b32 v217, v60, v61, s44
  v_perm_b32 v221, v62, v63, s44
  v_perm_b32 v225, v60, v61, s45
  v_perm_b32 v229, v62, v63, s45
  v_pk_lshrrev_b16 v60, s43, v70 op_sel:[0,1] op_sel_hi:[1,1]
  v_pk_lshrrev_b16 v62, s43, v71 op_sel:[0,1] op_sel_hi:[1,1]
  v_and_b32 v60, s41, v60
  v_and_b32 v62, s41, v62
  v_perm_b32 v61, v23, v22, v60
  v_perm_b32 v63, v27, v26, v62
  v_perm_b32 v60, v25, v24, v60
  v_perm_b32 v62, v29, v28, v62
  v_perm_b32 v224, v60, v61, s44
  v_perm_b32 v228, v62, v63, s44
  v_perm_b32 v218, v60, v61, s45
  v_perm_b32 v222, v62, v63, s45
  v_lshrrev_b64 v[56:57], 4, v[72:73]
  v_lshrrev_b64 v[58:59], 4, v[74:75]
  v_perm_b32 v72, v72, v56, s46
  v_perm_b32 v73, v73, v57, s46
  v_perm_b32 v74, v74, v58, s46
  v_perm_b32 v75, v75, v59, s46
  v_perm_b32 v56, v58, v56, s47
  v_perm_b32 v57, v59, v57, s47
  v_pk_lshrrev_b16 v60, s42, v72 op_sel:[0,0] op_sel_hi:[1,0]
  v_pk_lshrrev_b16 v62, s42, v73 op_sel:[0,0] op_sel_hi:[1,0]
  v_and_b32 v60, s41, v60
  v_and_b32 v62, s41, v62
  v_perm_b32 v61, v23, v22, v60
  v_perm_b32 v63, v27, v26, v62
  v_perm_b32 v60, v25, v24, v60
  v_perm_b32 v62, v29, v28, v62
  v_perm_b32 v226, v60, v61, s44
  v_perm_b32 v230, v62, v63, s44
  v_perm_b32 v234, v60, v61, s45
  v_perm_b32 v238, v62, v63, s45
  v_pk_lshrrev_b16 v60, s43, v72 op_sel:[0,1] op_sel_hi:[1,1]
  v_pk_lshrrev_b16 v62, s43, v73 op_sel:[0,1] op_sel_hi:[1,1]
  v_and_b32 v60, s41, v60
  v_and_b32 v62, s41, v62
  v_perm_b32 v61, v23, v22, v60
  v_perm_b32 v63, v27, v26, v62
  v_perm_b32 v60, v25, v24, v60
  v_perm_b32 v62, v29, v28, v62
  v_perm_b32 v233, v60, v61, s44
  v_perm_b32 v237, v62, v63, s44
  v_perm_b32 v227, v60, v61, s45
  v_perm_b32 v231, v62, v63, s45
  v_pk_lshrrev_b16 v60, s42, v56 op_sel:[0,0] op_sel_hi:[1,0]
  v_pk_lshrrev_b16 v62, s42, v57 op_sel:[0,0] op_sel_hi:[1,0]
  v_and_b32 v60, s41, v60
  v_and_b32 v62, s41, v62
  v_perm_b32 v61, v23, v22, v60
  v_perm_b32 v63, v27, v26, v62
  v_perm_b32 v60, v25, v24, v60
  v_perm_b32 v62, v29, v28, v62
  v_perm_b32 v232, v60, v61, s44
  v_perm_b32 v236, v62, v63, s44
  v_perm_b32 v241, v60, v61, s45
  v_perm_b32 v245, v62, v63, s45
  v_pk_lshrrev_b16 v60, s42, v74 op_sel:[0,0] op_sel_hi:[1,0]
  v_pk_lshrrev_b16 v62, s42, v75 op_sel:[0,0] op_sel_hi:[1,0]
  v_and_b32 v60, s41, v60
  v_and_b32 v62, s41, v62
  v_perm_b32 v61, v23, v22, v60
  v_perm_b32 v63, v27, v26, v62
  v_perm_b32 v60, v25, v24, v60
  v_perm_b32 v62, v29, v28, v62
  v_perm_b32 v235, v60, v61, s44
  v_perm_b32 v239, v62, v63, s44
  v_perm_b32 v243, v60, v61, s45
  v_perm_b32 v247, v62, v63, s45
  v_pk_lshrrev_b16 v60, s43, v74 op_sel:[0,1] op_sel_hi:[1,1]
  v_pk_lshrrev_b16 v62, s43, v75 op_sel:[0,1] op_sel_hi:[1,1]
  v_and_b32 v60, s41, v60
  v_and_b32 v62, s41, v62
  v_perm_b32 v61, v23, v22, v60
  v_perm_b32 v63, v27, v26, v62
  v_perm_b32 v60, v25, v24, v60
  v_perm_b32 v62, v29, v28, v62
  v_perm_b32 v242, v60, v61, s44
  v_perm_b32 v246, v62, v63, s44
  v_perm_b32 v240, v60, v61, s45
  v_perm_b32 v244, v62, v63, s45
  s_cmp_eq_u32 s35, 1
  s_cbranch_scc1 L_B
  s_nop 1
  s_add_u32 m0, s29, 0
  s_add_u32 s40, s28, 0
  buffer_load_dwordx4 v3, s[8:11], s40 offen  lds
  s_add_u32 m0, s29, 2064
  s_add_u32 s40, s28, 2040
  buffer_load_dwordx4 v3, s[8:11], s40 offen  lds
  s_add_u32 m0, s29, 4128
  s_add_u32 s40, s28, 4080
  buffer_load_dwordx4 v3, s[8:11], s40 offen  lds
  s_add_u32 m0, s29, 6192
  s_add_u32 s40, s28, 6120
  buffer_load_dwordx4 v3, s[8:11], s40 offen  lds
  s_add_u32 m0, s29, 33024
  s_add_u32 s40, s28, 32640
  buffer_load_dwordx4 v3, s[8:11], s40 offen  lds
  s_add_u32 m0, s29, 35088
  s_add_u32 s40, s28, 34680
  buffer_load_dwordx4 v3, s[8:11], s40 offen  lds
  s_add_u32 m0, s29, 37152
  s_add_u32 s40, s28, 36720
  buffer_load_dwordx4 v3, s[8:11], s40 offen  lds
  s_add_u32 m0, s29, 39216
  s_add_u32 s40, s28, 38760
  buffer_load_dwordx4 v3, s[8:11], s40 offen  lds
  s_add_u32 m0, s29, 66048
  s_add_u32 s40, s28, 65280
  buffer_load_dwordx4 v3, s[8:11], s40 offen  lds
  s_add_u32 m0, s29, 68112
  s_add_u32 s40, s28, 67320
  buffer_load_dwordx4 v3, s[8:11], s40 offen  lds
  s_add_u32 m0, s29, 70176
  s_add_u32 s40, s28, 69360
  buffer_load_dwordx4 v3, s[8:11], s40 offen  lds
  s_add_u32 m0, s29, 72240
  s_add_u32 s40, s28, 71400
  buffer_load_dwordx4 v3, s[8:11], s40 offen  lds
  s_add_u32 m0, s29, 0
  s_add_u32 s40, s28, 0
  buffer_load_dwordx4 v4, s[96:99], s40 offen offset:1024  lds
  s_add_u32 m0, s29, 2064
  s_add_u32 s40, s28, 2040
  buffer_load_dwordx4 v4, s[96:99], s40 offen offset:1024  lds
  s_add_u32 m0, s29, 4128
  s_add_u32 s40, s28, 4080
  buffer_load_dwordx4 v4, s[96:99], s40 offen offset:1024  lds
  s_add_u32 m0, s29, 6192
  s_add_u32 s40, s28, 6120
  buffer_load_dwordx4 v4, s[96:99], s40 offen offset:1024  lds
  s_waitcnt vmcnt(8)
  s_barrier
  ds_read_b128 v[32:35], v1 offset:0
  ds_read_b128 v[36:39], v1 offset:16
  ds_read_b128 v[40:43], v1 offset:32
  ds_read_b128 v[44:47], v1 offset:48
  ds_read_b128 v[48:51], v1 offset:64
  ds_read_b128 v[52:55], v1 offset:80
  ds_read_b128 v[56:59], v1 offset:96
  s_waitcnt lgkmcnt(5)
  v_mfma_f32_16x16x32_bf16 v[88:91], v[32:35], v[128:131], 0
  ds_read_b128 v[60:63], v1 offset:112
  v_mfma_f32_16x16x32_bf16 v[88:91], v[36:39], v[136:139], v[88:91]
  ds_read_b128 v[64:67], v1 offset:128
  s_waitcnt lgkmcnt(5)
  v_mfma_f32_16x16x32_bf16 v[88:91], v[40:43], v[144:147], v[88:91]
  ds_read_b128 v[68:71], v1 offset:144
  v_mfma_f32_16x16x32_bf16 v[88:91], v[44:47], v[152:155], v[88:91]
  ds_read_b128 v[72:75], v1 offset:160
  s_add_u32 m0, s29, 99072
  s_add_u32 s40, s28, 97920
  buffer_load_dwordx4 v3, s[8:11], s40 offen  lds
  v_mfma_f32_16x16x32_bf16 v[92:95], v[44:47], v[156:159], 0
  ds_read_b128 v[76:79], v1 offset:176
  v_mfma_f32_16x16x32_bf16 v[92:95], v[40:43], v[148:151], v[92:95]
  ds_read_b128 v[80:83], v1 offset:192
  v_mfma_f32_16x16x32_bf16 v[92:95], v[36:39], v[140:143], v[92:95]
  ds_read_b128 v[84:87], v1 offset:208
  v_mfma_f32_16x16x32_bf16 v[92:95], v[32:35], v[132:135], v[92:95]
  s_add_u32 m0, s29, 101136
  s_add_u32 s40, s28, 99960
  buffer_load_dwordx4 v3, s[8:11], s40 offen  lds
  s_waitcnt lgkmcnt(8)
  v_mfma_f32_16x16x32_bf16 v[92:95], v[48:51], v[164:167], v[92:95]
  ds_read_b128 v[44:47], v1 offset:224
  v_mfma_f32_16x16x32_bf16 v[92:95], v[52:55], v[172:175], v[92:95]
  s_waitcnt lgkmcnt(7)
  v_mfma_f32_16x16x32_bf16 v[92:95], v[56:59], v[180:183], v[92:95]
  ds_read_b128 v[40:43], v1 offset:240
  v_mfma_f32_16x16x32_bf16 v[92:95], v[60:63], v[188:191], v[92:95]
  s_add_u32 m0, s29, 103200
  s_add_u32 s40, s28, 102000
  buffer_load_dwordx4 v3, s[8:11], s40 offen  lds
  v_mfma_f32_16x16x32_bf16 v[88:91], v[60:63], v[184:187], v[88:91]
  ds_read_b128 v[36:39], v1 offset:33024
  v_mfma_f32_16x16x32_bf16 v[88:91], v[56:59], v[176:179], v[88:91]
  v_mfma_f32_16x16x32_bf16 v[88:91], v[52:55], v[168:171], v[88:91]
  ds_read_b128 v[32:35], v1 offset:33040
  v_mfma_f32_16x16x32_bf16 v[88:91], v[48:51], v[160:163], v[88:91]
  s_add_u32 m0, s29, 105264
  s_add_u32 s40, s28, 104040
  buffer_load_dwordx4 v3, s[8:11], s40 offen  lds
  s_waitcnt lgkmcnt(8)
  v_mfma_f32_16x16x32_bf16 v[88:91], v[64:67], v[192:195], v[88:91]
  ds_read_b128 v[60:63], v1 offset:33056
  v_mfma_f32_16x16x32_bf16 v[88:91], v[68:71], v[200:203], v[88:91]
  s_waitcnt lgkmcnt(7)
  v_mfma_f32_16x16x32_bf16 v[88:91], v[72:75], v[208:211], v[88:91]
  ds_read_b128 v[56:59], v1 offset:33072
  v_mfma_f32_16x16x32_bf16 v[88:91], v[76:79], v[216:219], v[88:91]
  s_add_u32 m0, s29, 33024
  s_add_u32 s40, s28, 32640
  buffer_load_dwordx4 v4, s[96:99], s40 offen offset:1024  lds
  v_mfma_f32_16x16x32_bf16 v[92:95], v[76:79], v[220:223], v[92:95]
  ds_read_b128 v[52:55], v1 offset:33088
  v_mfma_f32_16x16x32_bf16 v[92:95], v[72:75], v[212:215], v[92:95]
  v_mfma_f32_16x16x32_bf16 v[92:95], v[68:71], v[204:207], v[92:95]
  ds_read_b128 v[48:51], v1 offset:33104
  v_mfma_f32_16x16x32_bf16 v[92:95], v[64:67], v[196:199], v[92:95]
  s_add_u32 m0, s29, 35088
  s_add_u32 s40, s28, 34680
  buffer_load_dwordx4 v4, s[96:99], s40 offen offset:1024  lds
  s_waitcnt lgkmcnt(8)
  v_mfma_f32_16x16x32_bf16 v[92:95], v[80:83], v[228:231], v[92:95]
  ds_read_b128 v[76:79], v1 offset:33120
  v_mfma_f32_16x16x32_bf16 v[92:95], v[84:87], v[236:239], v[92:95]
  s_waitcnt lgkmcnt(7)
  v_mfma_f32_16x16x32_bf16 v[92:95], v[44:47], v[244:247], v[92:95]
  ds_read_b128 v[72:75], v1 offset:33136
  v_mfma_f32_16x16x32_bf16 v[92:95], v[40:43], v[252:255], v[92:95]
  s_add_u32 m0, s29, 37152
  s_add_u32 s40, s28, 36720
  buffer_load_dwordx4 v4, s[96:99], s40 offen offset:1024  lds
  v_mfma_f32_16x16x32_bf16 v[88:91], v[40:43], v[248:251], v[88:91]
  ds_read_b128 v[68:71], v1 offset:33152
  v_mfma_f32_16x16x32_bf16 v[88:91], v[44:47], v[240:243], v[88:91]
  v_mfma_f32_16x16x32_bf16 v[88:91], v[84:87], v[232:235], v[88:91]
  ds_read_b128 v[64:67], v1 offset:33168
  v_mfma_f32_16x16x32_bf16 v[88:91], v[80:83], v[224:227], v[88:91]
  s_add_u32 m0, s29, 39216
  s_add_u32 s40, s28, 38760
  buffer_load_dwordx4 v4, s[96:99], s40 offen offset:1024  lds
  s_waitcnt lgkmcnt(8)
  v_mfma_f32_16x16x32_bf16 v[96:99], v[36:39], v[128:131], 0
  ds_read_b128 v[40:43], v1 offset:33184
  v_mfma_f32_16x16x32_bf16 v[96:99], v[32:35], v[136:139], v[96:99]
  s_waitcnt lgkmcnt(7)
  v_mfma_f32_16x16x32_bf16 v[96:99], v[60:63], v[144:147], v[96:99]
  ds_read_b128 v[44:47], v1 offset:33200
  v_mfma_f32_16x16x32_bf16 v[96:99], v[56:59], v[152:155], v[96:99]
  s_add_u32 m0, s29, 66048
  s_add_u32 s40, s28, 65280
  buffer_load_dwordx4 v4, s[96:99], s40 offen offset:1024  lds
  v_mfma_f32_16x16x32_bf16 v[100:103], v[56:59], v[156:159], 0
  ds_read_b128 v[84:87], v1 offset:33216
  v_mfma_f32_16x16x32_bf16 v[100:103], v[60:63], v[148:151], v[100:103]
  v_mfma_f32_16x16x32_bf16 v[100:103], v[32:35], v[140:143], v[100:103]
  ds_read_b128 v[80:83], v1 offset:33232
  v_mfma_f32_16x16x32_bf16 v[100:103], v[36:39], v[132:135], v[100:103]
  s_add_u32 m0, s29, 68112
  s_add_u32 s40, s28, 67320
  buffer_load_dwordx4 v4, s[96:99], s40 offen offset:1024  lds
  s_waitcnt lgkmcnt(8)
  v_mfma_f32_16x16x32_bf16 v[100:103], v[52:55], v[164:167], v[100:103]
  ds_read_b128 v[56:59], v1 offset:33248
  v_mfma_f32_16x16x32_bf16 v[100:103], v[48:51], v[172:175], v[100:103]
  s_waitcnt lgkmcnt(7)
  v_mfma_f32_16x16x32_bf16 v[100:103], v[76:79], v[180:183], v[100:103]
  ds_read_b128 v[60:63], v1 offset:33264
  v_mfma_f32_16x16x32_bf16 v[100:103], v[72:75], v[188:191], v[100:103]
  s_add_u32 m0, s29, 70176
  s_add_u32 s40, s28, 69360
  buffer_load_dwordx4 v4, s[96:99], s40 offen offset:1024  lds
  v_mfma_f32_16x16x32_bf16 v[96:99], v[72:75], v[184:187], v[96:99]
  v_mfma_f32_16x16x32_bf16 v[96:99], v[76:79], v[176:179], v[96:99]
  v_mfma_f32_16x16x32_bf16 v[96:99], v[48:51], v[168:171], v[96:99]
  v_mfma_f32_16x16x32_bf16 v[96:99], v[52:55], v[160:163], v[96:99]
  s_add_u32 m0, s29, 72240
  s_add_u32 s40, s28, 71400
  buffer_load_dwordx4 v4, s[96:99], s40 offen offset:1024  lds
  s_waitcnt lgkmcnt(6)
  v_mfma_f32_16x16x32_bf16 v[96:99], v[68:71], v[192:195], v[96:99]
  v_mfma_f32_16x16x32_bf16 v[96:99], v[64:67], v[200:203], v[96:99]
  s_waitcnt lgkmcnt(5)
  v_mfma_f32_16x16x32_bf16 v[96:99], v[40:43], v[208:211], v[96:99]
  s_waitcnt lgkmcnt(4)
  v_mfma_f32_16x16x32_bf16 v[96:99], v[44:47], v[216:219], v[96:99]
  s_add_u32 m0, s29, 99072
  s_add_u32 s40, s28, 97920
  buffer_load_dwordx4 v4, s[96:99], s40 offen offset:1024  lds
  v_mfma_f32_16x16x32_bf16 v[100:103], v[44:47], v[220:223], v[100:103]
  v_mfma_f32_16x16x32_bf16 v[100:103], v[40:43], v[212:215], v[100:103]
  v_mfma_f32_16x16x32_bf16 v[100:103], v[64:67], v[204:207], v[100:103]
  v_mfma_f32_16x16x32_bf16 v[100:103], v[68:71], v[196:199], v[100:103]
  s_add_u32 m0, s29, 101136
  s_add_u32 s40, s28, 99960
  buffer_load_dwordx4 v4, s[96:99], s40 offen offset:1024  lds
  s_waitcnt lgkmcnt(3)
  v_mfma_f32_16x16x32_bf16 v[100:103], v[84:87], v[228:231], v[100:103]
  s_waitcnt lgkmcnt(2)
  v_mfma_f32_16x16x32_bf16 v[100:103], v[80:83], v[236:239], v[100:103]
  s_waitcnt lgkmcnt(1)
  v_mfma_f32_16x16x32_bf16 v[100:103], v[56:59], v[244:247], v[100:103]
  s_waitcnt lgkmcnt(0)
  v_mfma_f32_16x16x32_bf16 v[100:103], v[60:63], v[252:255], v[100:103]
  s_add_u32 m0, s29, 103200
  s_add_u32 s40, s28, 102000
  buffer_load_dwordx4 v4, s[96:99], s40 offen offset:1024  lds
  v_mfma_f32_16x16x32_bf16 v[96:99], v[60:63], v[248:251], v[96:99]
  v_mfma_f32_16x16x32_bf16 v[96:99], v[56:59], v[240:243], v[96:99]
  v_mfma_f32_16x16x32_bf16 v[96:99], v[80:83], v[232:235], v[96:99]
  v_mfma_f32_16x16x32_bf16 v[96:99], v[84:87], v[224:227], v[96:99]
  s_add_u32 m0, s29, 105264
  s_add_u32 s40, s28, 104040
  buffer_load_dwordx4 v4, s[96:99], s40 offen offset:1024  lds
  s_waitcnt vmcnt(8)
  s_barrier
  s_add_u32 s38, s7, 130560
  buffer_load_dwordx2 v[30:31], v9, s[8:11], s38 offen offset:60
  s_add_u32 s38, s7, 261120
  buffer_load_dwordx2 v[30:31], v9, s[8:11], s38 offen offset:60
  s_add_u32 s38, s7, 391680
  buffer_load_dwordx2 v[30:31], v9, s[8:11], s38 offen offset:60
  ds_read_b128 v[32:35], v2 offset:0
  ds_read_b128 v[36:39], v2 offset:16
  ds_read_b128 v[72:75], v2 offset:32
  ds_read_b128 v[76:79], v2 offset:48
  ds_read_b128 v[48:51], v2 offset:64
  ds_read_b128 v[52:55], v2 offset:80
  ds_read_b128 v[44:47], v2 offset:96
  s_waitcnt lgkmcnt(5)
  v_mfma_f32_16x16x32_bf16 v[104:107], v[32:35], v[128:131], 0
  ds_read_b128 v[40:43], v2 offset:112
  v_mfma_f32_16x16x32_bf16 v[104:107], v[36:39], v[136:139], v[104:107]
  ds_read_b128 v[64:67], v2 offset:128
  s_waitcnt lgkmcnt(5)
  v_mfma_f32_16x16x32_bf16 v[104:107], v[72:75], v[144:147], v[104:107]
  ds_read_b128 v[68:71], v2 offset:144
  v_mfma_f32_16x16x32_bf16 v[104:107], v[76:79], v[152:155], v[104:107]
  ds_read_b128 v[60:63], v2 offset:160
  v_mfma_f32_16x16x32_bf16 v[108:111], v[76:79], v[156:159], 0
  ds_read_b128 v[56:59], v2 offset:176
  v_mfma_f32_16x16x32_bf16 v[108:111], v[72:75], v[148:151], v[108:111]
  ds_read_b128 v[80:83], v2 offset:192
  v_mfma_f32_16x16x32_bf16 v[108:111], v[36:39], v[140:143], v[108:111]
  ds_read_b128 v[84:87], v2 offset:208
  v_mfma_f32_16x16x32_bf16 v[108:111], v[32:35], v[132:135], v[108:111]
  s_waitcnt lgkmcnt(8)
  v_mfma_f32_16x16x32_bf16 v[108:111], v[48:51], v[164:167], v[108:111]
  ds_read_b128 v[76:79], v2 offset:224
  v_mfma_f32_16x16x32_bf16 v[108:111], v[52:55], v[172:175], v[108:111]
  s_waitcnt lgkmcnt(7)
  v_mfma_f32_16x16x32_bf16 v[108:111], v[44:47], v[180:183], v[108:111]
  ds_read_b128 v[72:75], v2 offset:240
  v_mfma_f32_16x16x32_bf16 v[108:111], v[40:43], v[188:191], v[108:111]
  v_mfma_f32_16x16x32_bf16 v[104:107], v[40:43], v[184:187], v[104:107]
  ds_read_b128 v[36:39], v2 offset:33024
  v_mfma_f32_16x16x32_bf16 v[104:107], v[44:47], v[176:179], v[104:107]
  v_mfma_f32_16x16x32_bf16 v[104:107], v[52:55], v[168:171], v[104:107]
  ds_read_b128 v[32:35], v2 offset:33040
  v_mfma_f32_16x16x32_bf16 v[104:107], v[48:51], v[160:163], v[104:107]
  s_waitcnt lgkmcnt(8)
  v_mfma_f32_16x16x32_bf16 v[104:107], v[64:67], v[192:195], v[104:107]
  ds_read_b128 v[40:43], v2 offset:33056
  v_mfma_f32_16x16x32_bf16 v[104:107], v[68:71], v[200:203], v[104:107]
  s_waitcnt lgkmcnt(7)
  v_mfma_f32_16x16x32_bf16 v[104:107], v[60:63], v[208:211], v[104:107]
  ds_read_b128 v[44:47], v2 offset:33072
  v_mfma_f32_16x16x32_bf16 v[104:107], v[56:59], v[216:219], v[104:107]
  v_mfma_f32_16x16x32_bf16 v[108:111], v[56:59], v[220:223], v[108:111]
  ds_read_b128 v[52:55], v2 offset:33088
  v_mfma_f32_16x16x32_bf16 v[108:111], v[60:63], v[212:215], v[108:111]
  v_mfma_f32_16x16x32_bf16 v[108:111], v[68:71], v[204:207], v[108:111]
  ds_read_b128 v[48:51], v2 offset:33104
  v_mfma_f32_16x16x32_bf16 v[108:111], v[64:67], v[196:199], v[108:111]
  s_waitcnt lgkmcnt(8)
  v_mfma_f32_16x16x32_bf16 v[108:111], v[80:83], v[228:231], v[108:111]
  ds_read_b128 v[56:59], v2 offset:33120
  v_mfma_f32_16x16x32_bf16 v[108:111], v[84:87], v[236:239], v[108:111]
  s_waitcnt lgkmcnt(7)
  v_mfma_f32_16x16x32_bf16 v[108:111], v[76:79], v[244:247], v[108:111]
  ds_read_b128 v[60:63], v2 offset:33136
  v_mfma_f32_16x16x32_bf16 v[108:111], v[72:75], v[252:255], v[108:111]
  v_mfma_f32_16x16x32_bf16 v[104:107], v[72:75], v[248:251], v[104:107]
  ds_read_b128 v[68:71], v2 offset:33152
  v_mfma_f32_16x16x32_bf16 v[104:107], v[76:79], v[240:243], v[104:107]
  v_mfma_f32_16x16x32_bf16 v[104:107], v[84:87], v[232:235], v[104:107]
  ds_read_b128 v[64:67], v2 offset:33168
  v_mfma_f32_16x16x32_bf16 v[104:107], v[80:83], v[224:227], v[104:107]
  s_waitcnt lgkmcnt(8)
  v_mfma_f32_16x16x32_bf16 v[112:115], v[36:39], v[128:131], 0
  ds_read_b128 v[72:75], v2 offset:33184
  v_mfma_f32_16x16x32_bf16 v[112:115], v[32:35], v[136:139], v[112:115]
  s_waitcnt lgkmcnt(7)
  v_mfma_f32_16x16x32_bf16 v[112:115], v[40:43], v[144:147], v[112:115]
  ds_read_b128 v[76:79], v2 offset:33200
  v_mfma_f32_16x16x32_bf16 v[112:115], v[44:47], v[152:155], v[112:115]
  v_mfma_f32_16x16x32_bf16 v[116:119], v[44:47], v[156:159], 0
  ds_read_b128 v[84:87], v2 offset:33216
  v_mfma_f32_16x16x32_bf16 v[116:119], v[40:43], v[148:151], v[116:119]
  v_mfma_f32_16x16x32_bf16 v[116:119], v[32:35], v[140:143], v[116:119]
  ds_read_b128 v[80:83], v2 offset:33232
  v_mfma_f32_16x16x32_bf16 v[116:119], v[36:39], v[132:135], v[116:119]
  s_waitcnt lgkmcnt(8)
  v_mfma_f32_16x16x32_bf16 v[116:119], v[52:55], v[164:167], v[116:119]
  ds_read_b128 v[44:47], v2 offset:33248
  v_mfma_f32_16x16x32_bf16 v[116:119], v[48:51], v[172:175], v[116:119]
  s_waitcnt lgkmcnt(7)
  v_mfma_f32_16x16x32_bf16 v[116:119], v[56:59], v[180:183], v[116:119]
  ds_read_b128 v[40:43], v2 offset:33264
  v_mfma_f32_16x16x32_bf16 v[116:119], v[60:63], v[188:191], v[116:119]
  v_mfma_f32_16x16x32_bf16 v[112:115], v[60:63], v[184:187], v[112:115]
  v_mfma_f32_16x16x32_bf16 v[112:115], v[56:59], v[176:179], v[112:115]
  v_mfma_f32_16x16x32_bf16 v[112:115], v[48:51], v[168:171], v[112:115]
  v_mfma_f32_16x16x32_bf16 v[112:115], v[52:55], v[160:163], v[112:115]
  s_waitcnt lgkmcnt(6)
  v_mfma_f32_16x16x32_bf16 v[112:115], v[68:71], v[192:195], v[112:115]
  v_mfma_f32_16x16x32_bf16 v[112:115], v[64:67], v[200:203], v[112:115]
  s_waitcnt lgkmcnt(5)
  v_mfma_f32_16x16x32_bf16 v[112:115], v[72:75], v[208:211], v[112:115]
  s_waitcnt lgkmcnt(4)
  v_mfma_f32_16x16x32_bf16 v[112:115], v[76:79], v[216:219], v[112:115]
  v_mfma_f32_16x16x32_bf16 v[116:119], v[76:79], v[220:223], v[116:119]
  v_mfma_f32_16x16x32_bf16 v[116:119], v[72:75], v[212:215], v[116:119]
  v_mfma_f32_16x16x32_bf16 v[116:119], v[64:67], v[204:207], v[116:119]
  v_mfma_f32_16x16x32_bf16 v[116:119], v[68:71], v[196:199], v[116:119]
  s_waitcnt lgkmcnt(3)
  v_mfma_f32_16x16x32_bf16 v[116:119], v[84:87], v[228:231], v[116:119]
  s_waitcnt lgkmcnt(2)
  v_mfma_f32_16x16x32_bf16 v[116:119], v[80:83], v[236:239], v[116:119]
  s_waitcnt lgkmcnt(1)
  v_mfma_f32_16x16x32_bf16 v[116:119], v[44:47], v[244:247], v[116:119]
  s_waitcnt lgkmcnt(0)
  v_mfma_f32_16x16x32_bf16 v[116:119], v[40:43], v[252:255], v[116:119]
  v_mfma_f32_16x16x32_bf16 v[112:115], v[40:43], v[248:251], v[112:115]
  v_mfma_f32_16x16x32_bf16 v[112:115], v[44:47], v[240:243], v[112:115]
  v_mfma_f32_16x16x32_bf16 v[112:115], v[80:83], v[232:235], v[112:115]
  v_mfma_f32_16x16x32_bf16 v[112:115], v[84:87], v[224:227], v[112:115]
  s_setprio 0
  s_waitcnt vmcnt(3)
  s_barrier
  s_add_u32 m0, s29, 0
  s_add_u32 s40, s28, 130560
  buffer_load_dwordx4 v3, s[8:11], s40 offen  lds
  buffer_load_dwordx4 v4, s[96:99], s40 offen offset:1024  lds
  s_add_u32 m0, s29, 2064
  s_add_u32 s40, s28, 132600
  buffer_load_dwordx4 v3, s[8:11], s40 offen  lds
  buffer_load_dwordx4 v4, s[96:99], s40 offen offset:1024  lds
  s_add_u32 m0, s29, 4128
  s_add_u32 s40, s28, 134640
  buffer_load_dwordx4 v3, s[8:11], s40 offen  lds
  buffer_load_dwordx4 v4, s[96:99], s40 offen offset:1024  lds
  s_add_u32 m0, s29, 6192
  s_add_u32 s40, s28, 136680
  buffer_load_dwordx4 v3, s[8:11], s40 offen  lds
  buffer_load_dwordx4 v4, s[96:99], s40 offen offset:1024  lds
  s_barrier
  ds_read_b128 v[10:13], v7 offset:0
  ds_read_b128 v[14:17], v7 offset:4096
  s_add_u32 m0, s29, 33024
  s_add_u32 s40, s28, 163200
  buffer_load_dwordx4 v3, s[8:11], s40 offen  lds
  buffer_load_dwordx4 v4, s[96:99], s40 offen offset:1024  lds
  s_waitcnt lgkmcnt(0)
  v_add_f32 v88, v88, v10
  v_add_f32 v92, v92, v14
  v_add_f32 v90, v90, v12
  s_add_u32 m0, s29, 35088
  s_add_u32 s40, s28, 165240
  buffer_load_dwordx4 v3, s[8:11], s40 offen  lds
  v_add_f32 v94, v94, v16
  v_add_f32 v89, v89, v11
  v_add_f32_e64 v93, v93, v15
  buffer_load_dwordx4 v4, s[96:99], s40 offen offset:1024  lds
  v_add_f32 v91, v91, v13
  v_add_f32 v95, v95, v17
  v_cvt_pk_bf16_f32 v10, v88, v92
  s_add_u32 m0, s29, 37152
  s_add_u32 s40, s28, 167280
  buffer_load_dwordx4 v3, s[8:11], s40 offen  lds
  v_cvt_pk_bf16_f32 v12, v90, v94
  v_cvt_pk_bf16_f32 v11, v89, v93
  v_cvt_pk_bf16_f32 v13, v91, v95
  buffer_load_dwordx4 v4, s[96:99], s40 offen offset:1024  lds
  v_mov_b32 v14, v10
  v_mov_b32 v15, v11
  v_mov_b32_dpp v10, v12 row_ror:8 row_mask:0xf bank_mask:0xc
  s_add_u32 m0, s29, 39216
  s_add_u32 s40, s28, 169320
  buffer_load_dwordx4 v3, s[8:11], s40 offen  lds
  v_mov_b32_dpp v11, v13 row_ror:8 row_mask:0xf bank_mask:0xc
  v_mov_b32_dpp v12, v14 row_ror:8 row_mask:0xf bank_mask:0x3
  v_mov_b32_dpp v13, v15 row_ror:8 row_mask:0xf bank_mask:0x3
  buffer_load_dwordx4 v4, s[96:99], s40 offen offset:1024  lds
  v_mov_b32 v14, v10
  v_mov_b32 v15, v12
  v_mov_b32_dpp v10, v11 row_shr:4 row_mask:0xf bank_mask:0xa
  v_mov_b32_dpp v12, v13 row_shr:4 row_mask:0xf bank_mask:0xa
  v_mov_b32_dpp v11, v14 row_shl:4 row_mask:0xf bank_mask:0x5
  v_mov_b32_dpp v13, v15 row_shl:4 row_mask:0xf bank_mask:0x5
  s_add_u32 s39, s32, 0
  buffer_store_dwordx4 v[10:13], v8, s[24:27], s39 offen sc1
  s_waitcnt vmcnt(9)
  s_barrier
  ds_read_b128 v[18:21], v7 offset:8192
  ds_read_b128 v[22:25], v7 offset:12288
  s_add_u32 m0, s29, 66048
  s_add_u32 s40, s28, 195840
  buffer_load_dwordx4 v3, s[8:11], s40 offen  lds
  buffer_load_dwordx4 v4, s[96:99], s40 offen offset:1024  lds
  s_waitcnt lgkmcnt(0)
  v_add_f32 v96, v96, v18
  v_add_f32 v100, v100, v22
  v_add_f32_e64 v98, v98, v20
  s_add_u32 m0, s29, 68112
  s_add_u32 s40, s28, 197880
  buffer_load_dwordx4 v3, s[8:11], s40 offen  lds
  v_add_f32 v102, v102, v24
  v_add_f32 v97, v97, v19
  v_add_f32_e64 v101, v101, v23
  buffer_load_dwordx4 v4, s[96:99], s40 offen offset:1024  lds
  v_add_f32 v99, v99, v21
  v_add_f32 v103, v103, v25
  v_cvt_pk_bf16_f32 v18, v96, v100
  s_add_u32 m0, s29, 70176
  s_add_u32 s40, s28, 199920
  buffer_load_dwordx4 v3, s[8:11], s40 offen  lds
  v_cvt_pk_bf16_f32 v20, v98, v102
  v_cvt_pk_bf16_f32 v19, v97, v101
  v_cvt_pk_bf16_f32 v21, v99, v103
  buffer_load_dwordx4 v4, s[96:99], s40 offen offset:1024  lds
  v_mov_b32 v22, v18
  v_mov_b32 v23, v19
  v_mov_b32_dpp v18, v20 row_ror:8 row_mask:0xf bank_mask:0xc
  s_add_u32 m0, s29, 72240
  s_add_u32 s40, s28, 201960
  buffer_load_dwordx4 v3, s[8:11], s40 offen  lds
  v_mov_b32_dpp v19, v21 row_ror:8 row_mask:0xf bank_mask:0xc
  v_mov_b32_dpp v20, v22 row_ror:8 row_mask:0xf bank_mask:0x3
  v_mov_b32_dpp v21, v23 row_ror:8 row_mask:0xf bank_mask:0x3
  buffer_load_dwordx4 v4, s[96:99], s40 offen offset:1024  lds
  v_mov_b32 v22, v18
  v_mov_b32 v23, v20
  v_mov_b32_dpp v18, v19 row_shr:4 row_mask:0xf bank_mask:0xa
  v_mov_b32_dpp v20, v21 row_shr:4 row_mask:0xf bank_mask:0xa
  v_mov_b32_dpp v19, v22 row_shl:4 row_mask:0xf bank_mask:0x5
  v_mov_b32_dpp v21, v23 row_shl:4 row_mask:0xf bank_mask:0x5
  s_add_u32 s39, s32, 114688
  buffer_store_dwordx4 v[18:21], v8, s[24:27], s39 offen sc1
  ds_read_b128 v[32:35], v1 offset:0
  ds_read_b128 v[36:39], v1 offset:16
  ds_read_b128 v[60:63], v1 offset:32
  ds_read_b128 v[56:59], v1 offset:48
  ds_read_b128 v[48:51], v1 offset:64
  ds_read_b128 v[52:55], v1 offset:80
  ds_read_b128 v[76:79], v1 offset:96
  ds_read_b128 v[72:75], v1 offset:112
  ds_read_b128 v[64:67], v1 offset:128
  ds_read_b128 v[68:71], v1 offset:144
  ds_read_b128 v[40:43], v1 offset:160
  ds_read_b128 v[44:47], v1 offset:176
  s_waitcnt vmcnt(10)
  s_barrier
  ds_read_b128 v[10:13], v7 offset:16384
  ds_read_b128 v[14:17], v7 offset:20480
  s_add_u32 m0, s29, 99072
  s_add_u32 s40, s28, 228480
  buffer_load_dwordx4 v3, s[8:11], s40 offen  lds
  buffer_load_dwordx4 v4, s[96:99], s40 offen offset:1024  lds
  s_waitcnt lgkmcnt(0)
  v_add_f32 v104, v104, v10
  v_add_f32 v108, v108, v14
  v_add_f32 v106, v106, v12
  v_add_f32 v110, v110, v16
  v_add_f32 v105, v105, v11
  v_add_f32 v109, v109, v15
  v_add_f32 v107, v107, v13
  v_add_f32_e64 v111, v111, v17
  v_cvt_pk_bf16_f32 v10, v104, v108
  v_cvt_pk_bf16_f32 v12, v106, v110
  v_cvt_pk_bf16_f32 v11, v105, v109
  v_cvt_pk_bf16_f32 v13, v107, v111
  v_mov_b32 v14, v10
  v_mov_b32 v15, v11
  v_mov_b32_dpp v10, v12 row_ror:8 row_mask:0xf bank_mask:0xc
  v_mov_b32_dpp v11, v13 row_ror:8 row_mask:0xf bank_mask:0xc
  v_mov_b32_dpp v12, v14 row_ror:8 row_mask:0xf bank_mask:0x3
  v_mov_b32_dpp v13, v15 row_ror:8 row_mask:0xf bank_mask:0x3
  v_mov_b32 v14, v10
  v_mov_b32 v15, v12
  v_mov_b32_dpp v10, v11 row_shr:4 row_mask:0xf bank_mask:0xa
  v_mov_b32_dpp v12, v13 row_shr:4 row_mask:0xf bank_mask:0xa
  v_mov_b32_dpp v11, v14 row_shl:4 row_mask:0xf bank_mask:0x5
  v_mov_b32_dpp v13, v15 row_shl:4 row_mask:0xf bank_mask:0x5
  s_add_u32 s39, s32, 229376
  buffer_store_dwordx4 v[10:13], v8, s[24:27], s39 offen sc1
  v_mfma_f32_16x16x32_bf16 v[120:123], v[32:35], v[128:131], 0
  v_mfma_f32_16x16x32_bf16 v[120:123], v[36:39], v[136:139], v[120:123]
  v_mfma_f32_16x16x32_bf16 v[120:123], v[60:63], v[144:147], v[120:123]
  v_mfma_f32_16x16x32_bf16 v[120:123], v[56:59], v[152:155], v[120:123]
  v_mfma_f32_16x16x32_bf16 v[124:127], v[56:59], v[156:159], 0
  v_mfma_f32_16x16x32_bf16 v[124:127], v[60:63], v[148:151], v[124:127]
  v_mfma_f32_16x16x32_bf16 v[124:127], v[36:39], v[140:143], v[124:127]
  v_mfma_f32_16x16x32_bf16 v[124:127], v[32:35], v[132:135], v[124:127]
  v_mfma_f32_16x16x32_bf16 v[124:127], v[48:51], v[164:167], v[124:127]
  v_mfma_f32_16x16x32_bf16 v[124:127], v[52:55], v[172:175], v[124:127]
  v_mfma_f32_16x16x32_bf16 v[124:127], v[76:79], v[180:183], v[124:127]
  v_mfma_f32_16x16x32_bf16 v[124:127], v[72:75], v[188:191], v[124:127]
  v_mfma_f32_16x16x32_bf16 v[120:123], v[72:75], v[184:187], v[120:123]
  v_mfma_f32_16x16x32_bf16 v[120:123], v[76:79], v[176:179], v[120:123]
  v_mfma_f32_16x16x32_bf16 v[120:123], v[52:55], v[168:171], v[120:123]
  ds_read_b128 v[80:83], v1 offset:192
  v_mfma_f32_16x16x32_bf16 v[120:123], v[48:51], v[160:163], v[120:123]
  ds_read_b128 v[84:87], v1 offset:208
  v_mfma_f32_16x16x32_bf16 v[120:123], v[64:67], v[192:195], v[120:123]
  ds_read_b128 v[56:59], v1 offset:224
  v_mfma_f32_16x16x32_bf16 v[120:123], v[68:71], v[200:203], v[120:123]
  ds_read_b128 v[60:63], v1 offset:240
  v_mfma_f32_16x16x32_bf16 v[120:123], v[40:43], v[208:211], v[120:123]
  ds_read_b128 v[36:39], v1 offset:33024
  v_mfma_f32_16x16x32_bf16 v[120:123], v[44:47], v[216:219], v[120:123]
  ds_read_b128 v[32:35], v1 offset:33040
  v_mfma_f32_16x16x32_bf16 v[124:127], v[44:47], v[220:223], v[124:127]
  ds_read_b128 v[72:75], v1 offset:33056
  v_mfma_f32_16x16x32_bf16 v[124:127], v[40:43], v[212:215], v[124:127]
  ds_read_b128 v[76:79], v1 offset:33072
  v_mfma_f32_16x16x32_bf16 v[124:127], v[68:71], v[204:207], v[124:127]
  ds_read_b128 v[52:55], v1 offset:33088
  v_mfma_f32_16x16x32_bf16 v[124:127], v[64:67], v[196:199], v[124:127]
  ds_read_b128 v[48:51], v1 offset:33104
  s_waitcnt lgkmcnt(8)
  v_mfma_f32_16x16x32_bf16 v[124:127], v[80:83], v[228:231], v[124:127]
  ds_read_b128 v[44:47], v1 offset:33120
  v_mfma_f32_16x16x32_bf16 v[124:127], v[84:87], v[236:239], v[124:127]
  s_waitcnt lgkmcnt(7)
  v_mfma_f32_16x16x32_bf16 v[124:127], v[56:59], v[244:247], v[124:127]
  ds_read_b128 v[40:43], v1 offset:33136
  v_mfma_f32_16x16x32_bf16 v[124:127], v[60:63], v[252:255], v[124:127]
  v_mfma_f32_16x16x32_bf16 v[120:123], v[60:63], v[248:251], v[120:123]
  ds_read_b128 v[68:71], v1 offset:33152
  v_mfma_f32_16x16x32_bf16 v[120:123], v[56:59], v[240:243], v[120:123]
  v_mfma_f32_16x16x32_bf16 v[120:123], v[84:87], v[232:235], v[120:123]
  ds_read_b128 v[64:67], v1 offset:33168
  v_mfma_f32_16x16x32_bf16 v[120:123], v[80:83], v[224:227], v[120:123]
  s_waitcnt vmcnt(4)
  s_barrier
  ds_read_b128 v[18:21], v7 offset:0
  ds_read_b128 v[22:25], v7 offset:4096
  ds_read_b128 v[10:13], v7 offset:8192
  ds_read_b128 v[14:17], v7 offset:12288
  ds_read_b128 v[60:63], v1 offset:33184
  ds_read_b128 v[56:59], v1 offset:33200
  s_add_u32 m0, s29, 0
  s_add_u32 s40, s28, 261120
  buffer_load_dwordx4 v3, s[8:11], s40 offen  lds
  s_waitcnt lgkmcnt(4)
  v_add_f32 v112, v112, v18
  v_add_f32 v116, v116, v22
  v_add_f32 v114, v114, v20
  v_add_f32 v118, v118, v24
  v_add_f32 v113, v113, v19
  v_add_f32 v117, v117, v23
  v_add_f32 v115, v115, v21
  v_add_f32 v119, v119, v25
  v_cvt_pk_bf16_f32 v18, v112, v116
  v_cvt_pk_bf16_f32 v20, v114, v118
  v_cvt_pk_bf16_f32 v19, v113, v117
  v_cvt_pk_bf16_f32 v21, v115, v119
  v_mov_b32 v22, v18
  v_mov_b32 v23, v19
  v_mov_b32_dpp v18, v20 row_ror:8 row_mask:0xf bank_mask:0xc
  v_mov_b32_dpp v19, v21 row_ror:8 row_mask:0xf bank_mask:0xc
  v_mov_b32_dpp v20, v22 row_ror:8 row_mask:0xf bank_mask:0x3
  v_mov_b32_dpp v21, v23 row_ror:8 row_mask:0xf bank_mask:0x3
  v_mov_b32 v22, v18
  v_mov_b32 v23, v20
  v_mov_b32_dpp v18, v19 row_shr:4 row_mask:0xf bank_mask:0xa
  v_mov_b32_dpp v20, v21 row_shr:4 row_mask:0xf bank_mask:0xa
  v_mov_b32_dpp v19, v22 row_shl:4 row_mask:0xf bank_mask:0x5
  v_mov_b32_dpp v21, v23 row_shl:4 row_mask:0xf bank_mask:0x5
  s_add_u32 s39, s32, 344064
  buffer_store_dwordx4 v[18:21], v8, s[24:27], s39 offen sc1
  s_waitcnt lgkmcnt(2)
  v_add_f32 v120, v120, v10
  v_add_f32 v124, v124, v14
  v_add_f32 v122, v122, v12
  v_add_f32 v126, v126, v16
  v_add_f32 v121, v121, v11
  v_add_f32 v125, v125, v15
  v_add_f32 v123, v123, v13
  v_add_f32_e64 v127, v127, v17
  v_cvt_pk_bf16_f32 v10, v120, v124
  v_cvt_pk_bf16_f32 v12, v122, v126
  v_cvt_pk_bf16_f32 v11, v121, v125
  v_cvt_pk_bf16_f32 v13, v123, v127
  v_mov_b32 v14, v10
  v_mov_b32 v15, v11
  v_mov_b32_dpp v10, v12 row_ror:8 row_mask:0xf bank_mask:0xc
  v_mov_b32_dpp v11, v13 row_ror:8 row_mask:0xf bank_mask:0xc
  v_mov_b32_dpp v12, v14 row_ror:8 row_mask:0xf bank_mask:0x3
  v_mov_b32_dpp v13, v15 row_ror:8 row_mask:0xf bank_mask:0x3
  v_mov_b32 v14, v10
  v_mov_b32 v15, v12
  v_mov_b32_dpp v10, v11 row_shr:4 row_mask:0xf bank_mask:0xa
  v_mov_b32_dpp v12, v13 row_shr:4 row_mask:0xf bank_mask:0xa
  v_mov_b32_dpp v11, v14 row_shl:4 row_mask:0xf bank_mask:0x5
  v_mov_b32_dpp v13, v15 row_shl:4 row_mask:0xf bank_mask:0x5
  s_add_u32 s39, s32, 458752
  buffer_store_dwordx4 v[10:13], v8, s[24:27], s39 offen sc1
  v_mfma_f32_16x16x32_bf16 v[88:91], v[36:39], v[128:131], 0
  v_mfma_f32_16x16x32_bf16 v[88:91], v[32:35], v[136:139], v[88:91]
  v_mfma_f32_16x16x32_bf16 v[88:91], v[72:75], v[144:147], v[88:91]
  v_mfma_f32_16x16x32_bf16 v[88:91], v[76:79], v[152:155], v[88:91]
  v_mfma_f32_16x16x32_bf16 v[92:95], v[76:79], v[156:159], 0
  v_mfma_f32_16x16x32_bf16 v[92:95], v[72:75], v[148:151], v[92:95]
  v_mfma_f32_16x16x32_bf16 v[92:95], v[32:35], v[140:143], v[92:95]
  v_mfma_f32_16x16x32_bf16 v[92:95], v[36:39], v[132:135], v[92:95]
  v_mfma_f32_16x16x32_bf16 v[92:95], v[52:55], v[164:167], v[92:95]
  v_mfma_f32_16x16x32_bf16 v[92:95], v[48:51], v[172:175], v[92:95]
  v_mfma_f32_16x16x32_bf16 v[92:95], v[44:47], v[180:183], v[92:95]
  v_mfma_f32_16x16x32_bf16 v[92:95], v[40:43], v[188:191], v[92:95]
  v_mfma_f32_16x16x32_bf16 v[88:91], v[40:43], v[184:187], v[88:91]
  v_mfma_f32_16x16x32_bf16 v[88:91], v[44:47], v[176:179], v[88:91]
  v_mfma_f32_16x16x32_bf16 v[88:91], v[48:51], v[168:171], v[88:91]
  ds_read_b128 v[84:87], v1 offset:33216
  v_mfma_f32_16x16x32_bf16 v[88:91], v[52:55], v[160:163], v[88:91]
  ds_read_b128 v[80:83], v1 offset:33232
  v_mfma_f32_16x16x32_bf16 v[88:91], v[68:71], v[192:195], v[88:91]
  ds_read_b128 v[76:79], v1 offset:33248
  v_mfma_f32_16x16x32_bf16 v[88:91], v[64:67], v[200:203], v[88:91]
  ds_read_b128 v[72:75], v1 offset:33264
  s_waitcnt lgkmcnt(5)
  v_mfma_f32_16x16x32_bf16 v[88:91], v[60:63], v[208:211], v[88:91]
  ds_read_b128 v[32:35], v2 offset:0
  s_waitcnt lgkmcnt(5)
  v_mfma_f32_16x16x32_bf16 v[88:91], v[56:59], v[216:219], v[88:91]
  ds_read_b128 v[36:39], v2 offset:16
  v_mfma_f32_16x16x32_bf16 v[92:95], v[56:59], v[220:223], v[92:95]
  ds_read_b128 v[40:43], v2 offset:32
  v_mfma_f32_16x16x32_bf16 v[92:95], v[60:63], v[212:215], v[92:95]
  ds_read_b128 v[44:47], v2 offset:48
  v_mfma_f32_16x16x32_bf16 v[92:95], v[64:67], v[204:207], v[92:95]
  ds_read_b128 v[48:51], v2 offset:64
  v_mfma_f32_16x16x32_bf16 v[92:95], v[68:71], v[196:199], v[92:95]
  ds_read_b128 v[52:55], v2 offset:80
  s_waitcnt lgkmcnt(8)
  v_mfma_f32_16x16x32_bf16 v[92:95], v[84:87], v[228:231], v[92:95]
  ds_read_b128 v[56:59], v2 offset:96
  v_mfma_f32_16x16x32_bf16 v[92:95], v[80:83], v[236:239], v[92:95]
  s_waitcnt lgkmcnt(7)
  v_mfma_f32_16x16x32_bf16 v[92:95], v[76:79], v[244:247], v[92:95]
  ds_read_b128 v[60:63], v2 offset:112
  v_mfma_f32_16x16x32_bf16 v[92:95], v[72:75], v[252:255], v[92:95]
  v_mfma_f32_16x16x32_bf16 v[88:91], v[72:75], v[248:251], v[88:91]
  ds_read_b128 v[64:67], v2 offset:128
  v_mfma_f32_16x16x32_bf16 v[88:91], v[76:79], v[240:243], v[88:91]
  v_mfma_f32_16x16x32_bf16 v[88:91], v[80:83], v[232:235], v[88:91]
  ds_read_b128 v[68:71], v2 offset:144
  v_mfma_f32_16x16x32_bf16 v[88:91], v[84:87], v[224:227], v[88:91]
  s_waitcnt vmcnt(4)
  s_barrier
  ds_read_b128 v[18:21], v7 offset:16384
  ds_read_b128 v[22:25], v7 offset:20480
  ds_read_b128 v[72:75], v2 offset:160
  ds_read_b128 v[76:79], v2 offset:176
  s_add_u32 m0, s29, 33024
  s_add_u32 s40, s28, 293760
  buffer_load_dwordx4 v3, s[8:11], s40 offen  lds
  buffer_load_dwordx4 v4, s[96:99], s40 offen offset:1024  lds
  s_waitcnt lgkmcnt(2)
  v_add_f32 v88, v88, v18
  v_add_f32 v92, v92, v22
  v_add_f32 v90, v90, v20
  v_add_f32 v94, v94, v24
  v_add_f32 v89, v89, v19
  v_add_f32 v93, v93, v23
  v_add_f32 v91, v91, v21
  v_add_f32_e64 v95, v95, v25
  v_cvt_pk_bf16_f32 v18, v88, v92
  v_cvt_pk_bf16_f32 v20, v90, v94
  v_cvt_pk_bf16_f32 v19, v89, v93
  v_cvt_pk_bf16_f32 v21, v91, v95
  v_mov_b32 v22, v18
  v_mov_b32 v23, v19
  v_mov_b32_dpp v18, v20 row_ror:8 row_mask:0xf bank_mask:0xc
  v_mov_b32_dpp v19, v21 row_ror:8 row_mask:0xf bank_mask:0xc
  v_mov_b32_dpp v20, v22 row_ror:8 row_mask:0xf bank_mask:0x3
  v_mov_b32_dpp v21, v23 row_ror:8 row_mask:0xf bank_mask:0x3
  v_mov_b32 v22, v18
  v_mov_b32 v23, v20
  v_mov_b32_dpp v18, v19 row_shr:4 row_mask:0xf bank_mask:0xa
  v_mov_b32_dpp v20, v21 row_shr:4 row_mask:0xf bank_mask:0xa
  v_mov_b32_dpp v19, v22 row_shl:4 row_mask:0xf bank_mask:0x5
  v_mov_b32_dpp v21, v23 row_shl:4 row_mask:0xf bank_mask:0x5
  s_add_u32 s39, s32, 573440
  buffer_store_dwordx4 v[18:21], v8, s[24:27], s39 offen sc1
  v_mfma_f32_16x16x32_bf16 v[96:99], v[32:35], v[128:131], 0
  v_mfma_f32_16x16x32_bf16 v[96:99], v[36:39], v[136:139], v[96:99]
  v_mfma_f32_16x16x32_bf16 v[96:99], v[40:43], v[144:147], v[96:99]
  v_mfma_f32_16x16x32_bf16 v[96:99], v[44:47], v[152:155], v[96:99]
  v_mfma_f32_16x16x32_bf16 v[100:103], v[44:47], v[156:159], 0
  v_mfma_f32_16x16x32_bf16 v[100:103], v[40:43], v[148:151], v[100:103]
  v_mfma_f32_16x16x32_bf16 v[100:103], v[36:39], v[140:143], v[100:103]
  v_mfma_f32_16x16x32_bf16 v[100:103], v[32:35], v[132:135], v[100:103]
  v_mfma_f32_16x16x32_bf16 v[100:103], v[48:51], v[164:167], v[100:103]
  v_mfma_f32_16x16x32_bf16 v[100:103], v[52:55], v[172:175], v[100:103]
  v_mfma_f32_16x16x32_bf16 v[100:103], v[56:59], v[180:183], v[100:103]
  v_mfma_f32_16x16x32_bf16 v[100:103], v[60:63], v[188:191], v[100:103]
  v_mfma_f32_16x16x32_bf16 v[96:99], v[60:63], v[184:187], v[96:99]
  v_mfma_f32_16x16x32_bf16 v[96:99], v[56:59], v[176:179], v[96:99]
  v_mfma_f32_16x16x32_bf16 v[96:99], v[52:55], v[168:171], v[96:99]
  ds_read_b128 v[80:83], v2 offset:192
  v_mfma_f32_16x16x32_bf16 v[96:99], v[48:51], v[160:163], v[96:99]
  ds_read_b128 v[84:87], v2 offset:208
  v_mfma_f32_16x16x32_bf16 v[96:99], v[64:67], v[192:195], v[96:99]
  ds_read_b128 v[44:47], v2 offset:224
  v_mfma_f32_16x16x32_bf16 v[96:99], v[68:71], v[200:203], v[96:99]
  ds_read_b128 v[40:43], v2 offset:240
  s_waitcnt lgkmcnt(5)
  v_mfma_f32_16x16x32_bf16 v[96:99], v[72:75], v[208:211], v[96:99]
  ds_read_b128 v[36:39], v2 offset:33024
  s_waitcnt lgkmcnt(5)
  v_mfma_f32_16x16x32_bf16 v[96:99], v[76:79], v[216:219], v[96:99]
  ds_read_b128 v[32:35], v2 offset:33040
  v_mfma_f32_16x16x32_bf16 v[100:103], v[76:79], v[220:223], v[100:103]
  ds_read_b128 v[60:63], v2 offset:33056
  v_mfma_f32_16x16x32_bf16 v[100:103], v[72:75], v[212:215], v[100:103]
  ds_read_b128 v[56:59], v2 offset:33072
  v_mfma_f32_16x16x32_bf16 v[100:103], v[68:71], v[204:207], v[100:103]
  ds_read_b128 v[52:55], v2 offset:33088
  v_mfma_f32_16x16x32_bf16 v[100:103], v[64:67], v[196:199], v[100:103]
  ds_read_b128 v[48:51], v2 offset:33104
  s_waitcnt lgkmcnt(8)
  v_mfma_f32_16x16x32_bf16 v[100:103], v[80:83], v[228:231], v[100:103]
  ds_read_b128 v[76:79], v2 offset:33120
  v_mfma_f32_16x16x32_bf16 v[100:103], v[84:87], v[236:239], v[100:103]
  s_waitcnt lgkmcnt(7)
  v_mfma_f32_16x16x32_bf16 v[100:103], v[44:47], v[244:247], v[100:103]
  ds_read_b128 v[72:75], v2 offset:33136
  v_mfma_f32_16x16x32_bf16 v[100:103], v[40:43], v[252:255], v[100:103]
  v_mfma_f32_16x16x32_bf16 v[96:99], v[40:43], v[248:251], v[96:99]
  ds_read_b128 v[68:71], v2 offset:33152
  v_mfma_f32_16x16x32_bf16 v[96:99], v[44:47], v[240:243], v[96:99]
  v_mfma_f32_16x16x32_bf16 v[96:99], v[84:87], v[232:235], v[96:99]
  ds_read_b128 v[64:67], v2 offset:33168
  v_mfma_f32_16x16x32_bf16 v[96:99], v[80:83], v[224:227], v[96:99]
  s_waitcnt vmcnt(5)
  s_barrier
  ds_read_b128 v[10:13], v7 offset:0
  ds_read_b128 v[14:17], v7 offset:4096
  ds_read_b128 v[40:43], v2 offset:33184
  ds_read_b128 v[44:47], v2 offset:33200
  s_add_u32 m0, s29, 66048
  s_add_u32 s40, s28, 326400
  buffer_load_dwordx4 v3, s[8:11], s40 offen  lds
  buffer_load_dwordx4 v4, s[96:99], s40 offen offset:1024  lds
  s_waitcnt lgkmcnt(2)
  v_add_f32 v96, v96, v10
  v_add_f32 v100, v100, v14
  v_add_f32 v98, v98, v12
  v_add_f32 v102, v102, v16
  v_add_f32 v97, v97, v11
  v_add_f32 v101, v101, v15
  v_add_f32 v99, v99, v13
  v_add_f32_e64 v103, v103, v17
  v_cvt_pk_bf16_f32 v10, v96, v100
  v_cvt_pk_bf16_f32 v12, v98, v102
  v_cvt_pk_bf16_f32 v11, v97, v101
  v_cvt_pk_bf16_f32 v13, v99, v103
  v_mov_b32 v14, v10
  v_mov_b32 v15, v11
  v_mov_b32_dpp v10, v12 row_ror:8 row_mask:0xf bank_mask:0xc
  v_mov_b32_dpp v11, v13 row_ror:8 row_mask:0xf bank_mask:0xc
  v_mov_b32_dpp v12, v14 row_ror:8 row_mask:0xf bank_mask:0x3
  v_mov_b32_dpp v13, v15 row_ror:8 row_mask:0xf bank_mask:0x3
  v_mov_b32 v14, v10
  v_mov_b32 v15, v12
  v_mov_b32_dpp v10, v11 row_shr:4 row_mask:0xf bank_mask:0xa
  v_mov_b32_dpp v12, v13 row_shr:4 row_mask:0xf bank_mask:0xa
  v_mov_b32_dpp v11, v14 row_shl:4 row_mask:0xf bank_mask:0x5
  v_mov_b32_dpp v13, v15 row_shl:4 row_mask:0xf bank_mask:0x5
  s_add_u32 s39, s32, 688128
  buffer_store_dwordx4 v[10:13], v8, s[24:27], s39 offen sc1
  v_mfma_f32_16x16x32_bf16 v[104:107], v[36:39], v[128:131], 0
  v_mfma_f32_16x16x32_bf16 v[104:107], v[32:35], v[136:139], v[104:107]
  v_mfma_f32_16x16x32_bf16 v[104:107], v[60:63], v[144:147], v[104:107]
  v_mfma_f32_16x16x32_bf16 v[104:107], v[56:59], v[152:155], v[104:107]
  v_mfma_f32_16x16x32_bf16 v[108:111], v[56:59], v[156:159], 0
  v_mfma_f32_16x16x32_bf16 v[108:111], v[60:63], v[148:151], v[108:111]
  v_mfma_f32_16x16x32_bf16 v[108:111], v[32:35], v[140:143], v[108:111]
  v_mfma_f32_16x16x32_bf16 v[108:111], v[36:39], v[132:135], v[108:111]
  v_mfma_f32_16x16x32_bf16 v[108:111], v[52:55], v[164:167], v[108:111]
  v_mfma_f32_16x16x32_bf16 v[108:111], v[48:51], v[172:175], v[108:111]
  v_mfma_f32_16x16x32_bf16 v[108:111], v[76:79], v[180:183], v[108:111]
  v_mfma_f32_16x16x32_bf16 v[108:111], v[72:75], v[188:191], v[108:111]
  v_mfma_f32_16x16x32_bf16 v[104:107], v[72:75], v[184:187], v[104:107]
  v_mfma_f32_16x16x32_bf16 v[104:107], v[76:79], v[176:179], v[104:107]
  v_mfma_f32_16x16x32_bf16 v[104:107], v[48:51], v[168:171], v[104:107]
  ds_read_b128 v[84:87], v2 offset:33216
  v_mfma_f32_16x16x32_bf16 v[104:107], v[52:55], v[160:163], v[104:107]
  ds_read_b128 v[80:83], v2 offset:33232
  v_mfma_f32_16x16x32_bf16 v[104:107], v[68:71], v[192:195], v[104:107]
  ds_read_b128 v[56:59], v2 offset:33248
  v_mfma_f32_16x16x32_bf16 v[104:107], v[64:67], v[200:203], v[104:107]
  ds_read_b128 v[60:63], v2 offset:33264
  s_waitcnt lgkmcnt(5)
  v_mfma_f32_16x16x32_bf16 v[104:107], v[40:43], v[208:211], v[104:107]
  ds_read_b128 v[32:35], v1 offset:0
  s_waitcnt lgkmcnt(5)
  v_mfma_f32_16x16x32_bf16 v[104:107], v[44:47], v[216:219], v[104:107]
  ds_read_b128 v[36:39], v1 offset:16
  v_mfma_f32_16x16x32_bf16 v[108:111], v[44:47], v[220:223], v[108:111]
  ds_read_b128 v[72:75], v1 offset:32
  v_mfma_f32_16x16x32_bf16 v[108:111], v[40:43], v[212:215], v[108:111]
  ds_read_b128 v[76:79], v1 offset:48
  v_mfma_f32_16x16x32_bf16 v[108:111], v[64:67], v[204:207], v[108:111]
  ds_read_b128 v[48:51], v1 offset:64
  v_mfma_f32_16x16x32_bf16 v[108:111], v[68:71], v[196:199], v[108:111]
  ds_read_b128 v[52:55], v1 offset:80
  s_waitcnt lgkmcnt(8)
  v_mfma_f32_16x16x32_bf16 v[108:111], v[84:87], v[228:231], v[108:111]
  ds_read_b128 v[44:47], v1 offset:96
  v_mfma_f32_16x16x32_bf16 v[108:111], v[80:83], v[236:239], v[108:111]
  s_waitcnt lgkmcnt(7)
  v_mfma_f32_16x16x32_bf16 v[108:111], v[56:59], v[244:247], v[108:111]
  ds_read_b128 v[40:43], v1 offset:112
  v_mfma_f32_16x16x32_bf16 v[108:111], v[60:63], v[252:255], v[108:111]
  v_mfma_f32_16x16x32_bf16 v[104:107], v[60:63], v[248:251], v[104:107]
  ds_read_b128 v[64:67], v1 offset:128
  v_mfma_f32_16x16x32_bf16 v[104:107], v[56:59], v[240:243], v[104:107]
  v_mfma_f32_16x16x32_bf16 v[104:107], v[80:83], v[232:235], v[104:107]
  ds_read_b128 v[68:71], v1 offset:144
  v_mfma_f32_16x16x32_bf16 v[104:107], v[84:87], v[224:227], v[104:107]
  s_waitcnt vmcnt(4)
  s_barrier
  ds_read_b128 v[18:21], v7 offset:8192
  ds_read_b128 v[22:25], v7 offset:12288
  ds_read_b128 v[60:63], v1 offset:160
  ds_read_b128 v[56:59], v1 offset:176
  s_add_u32 m0, s29, 99072
  s_add_u32 s40, s28, 359040
  buffer_load_dwordx4 v3, s[8:11], s40 offen  lds
  buffer_load_dwordx4 v4, s[96:99], s40 offen offset:1024  lds
  s_waitcnt lgkmcnt(2)
  v_add_f32 v104, v104, v18
  v_add_f32 v108, v108, v22
  v_add_f32 v106, v106, v20
  v_add_f32 v110, v110, v24
  v_add_f32 v105, v105, v19
  v_add_f32 v109, v109, v23
  v_add_f32 v107, v107, v21
  v_add_f32_e64 v111, v111, v25
  v_cvt_pk_bf16_f32 v18, v104, v108
  v_cvt_pk_bf16_f32 v20, v106, v110
  v_cvt_pk_bf16_f32 v19, v105, v109
  v_cvt_pk_bf16_f32 v21, v107, v111
  v_mov_b32 v22, v18
  v_mov_b32 v23, v19
  v_mov_b32_dpp v18, v20 row_ror:8 row_mask:0xf bank_mask:0xc
  v_mov_b32_dpp v19, v21 row_ror:8 row_mask:0xf bank_mask:0xc
  v_mov_b32_dpp v20, v22 row_ror:8 row_mask:0xf bank_mask:0x3
  v_mov_b32_dpp v21, v23 row_ror:8 row_mask:0xf bank_mask:0x3
  v_mov_b32 v22, v18
  v_mov_b32 v23, v20
  v_mov_b32_dpp v18, v19 row_shr:4 row_mask:0xf bank_mask:0xa
  v_mov_b32_dpp v20, v21 row_shr:4 row_mask:0xf bank_mask:0xa
  v_mov_b32_dpp v19, v22 row_shl:4 row_mask:0xf bank_mask:0x5
  v_mov_b32_dpp v21, v23 row_shl:4 row_mask:0xf bank_mask:0x5
  s_add_u32 s39, s32, 802816
  buffer_store_dwordx4 v[18:21], v8, s[24:27], s39 offen sc1
  v_mfma_f32_16x16x32_bf16 v[112:115], v[32:35], v[128:131], 0
  v_mfma_f32_16x16x32_bf16 v[112:115], v[36:39], v[136:139], v[112:115]
  v_mfma_f32_16x16x32_bf16 v[112:115], v[72:75], v[144:147], v[112:115]
  v_mfma_f32_16x16x32_bf16 v[112:115], v[76:79], v[152:155], v[112:115]
  v_mfma_f32_16x16x32_bf16 v[116:119], v[76:79], v[156:159], 0
  v_mfma_f32_16x16x32_bf16 v[116:119], v[72:75], v[148:151], v[116:119]
  v_mfma_f32_16x16x32_bf16 v[116:119], v[36:39], v[140:143], v[116:119]
  v_mfma_f32_16x16x32_bf16 v[116:119], v[32:35], v[132:135], v[116:119]
  v_mfma_f32_16x16x32_bf16 v[116:119], v[48:51], v[164:167], v[116:119]
  v_mfma_f32_16x16x32_bf16 v[116:119], v[52:55], v[172:175], v[116:119]
  v_mfma_f32_16x16x32_bf16 v[116:119], v[44:47], v[180:183], v[116:119]
  v_mfma_f32_16x16x32_bf16 v[116:119], v[40:43], v[188:191], v[116:119]
  v_mfma_f32_16x16x32_bf16 v[112:115], v[40:43], v[184:187], v[112:115]
  v_mfma_f32_16x16x32_bf16 v[112:115], v[44:47], v[176:179], v[112:115]
  v_mfma_f32_16x16x32_bf16 v[112:115], v[52:55], v[168:171], v[112:115]
  ds_read_b128 v[80:83], v1 offset:192
  v_mfma_f32_16x16x32_bf16 v[112:115], v[48:51], v[160:163], v[112:115]
  ds_read_b128 v[84:87], v1 offset:208
  v_mfma_f32_16x16x32_bf16 v[112:115], v[64:67], v[192:195], v[112:115]
  ds_read_b128 v[76:79], v1 offset:224
  v_mfma_f32_16x16x32_bf16 v[112:115], v[68:71], v[200:203], v[112:115]
  ds_read_b128 v[72:75], v1 offset:240
  s_waitcnt lgkmcnt(5)
  v_mfma_f32_16x16x32_bf16 v[112:115], v[60:63], v[208:211], v[112:115]
  ds_read_b128 v[36:39], v1 offset:33024
  s_waitcnt lgkmcnt(5)
  v_mfma_f32_16x16x32_bf16 v[112:115], v[56:59], v[216:219], v[112:115]
  ds_read_b128 v[32:35], v1 offset:33040
  v_mfma_f32_16x16x32_bf16 v[116:119], v[56:59], v[220:223], v[116:119]
  ds_read_b128 v[40:43], v1 offset:33056
  v_mfma_f32_16x16x32_bf16 v[116:119], v[60:63], v[212:215], v[116:119]
  ds_read_b128 v[44:47], v1 offset:33072
  v_mfma_f32_16x16x32_bf16 v[116:119], v[68:71], v[204:207], v[116:119]
  ds_read_b128 v[52:55], v1 offset:33088
  v_mfma_f32_16x16x32_bf16 v[116:119], v[64:67], v[196:199], v[116:119]
  ds_read_b128 v[48:51], v1 offset:33104
  s_waitcnt lgkmcnt(8)
  v_mfma_f32_16x16x32_bf16 v[116:119], v[80:83], v[228:231], v[116:119]
  ds_read_b128 v[56:59], v1 offset:33120
  v_mfma_f32_16x16x32_bf16 v[116:119], v[84:87], v[236:239], v[116:119]
  s_waitcnt lgkmcnt(7)
  v_mfma_f32_16x16x32_bf16 v[116:119], v[76:79], v[244:247], v[116:119]
  ds_read_b128 v[60:63], v1 offset:33136
  v_mfma_f32_16x16x32_bf16 v[116:119], v[72:75], v[252:255], v[116:119]
  v_mfma_f32_16x16x32_bf16 v[112:115], v[72:75], v[248:251], v[112:115]
  ds_read_b128 v[68:71], v1 offset:33152
  v_mfma_f32_16x16x32_bf16 v[112:115], v[76:79], v[240:243], v[112:115]
  v_mfma_f32_16x16x32_bf16 v[112:115], v[84:87], v[232:235], v[112:115]
  ds_read_b128 v[64:67], v1 offset:33168
  v_mfma_f32_16x16x32_bf16 v[112:115], v[80:83], v[224:227], v[112:115]
  s_waitcnt vmcnt(4)
  s_barrier
  ds_read_b128 v[10:13], v7 offset:16384
  ds_read_b128 v[14:17], v7 offset:20480
  ds_read_b128 v[72:75], v1 offset:33184
  ds_read_b128 v[76:79], v1 offset:33200
  s_add_u32 m0, s29, 0
  s_add_u32 s40, s28, 391680
  buffer_load_dwordx4 v3, s[8:11], s40 offen  lds
  buffer_load_dwordx4 v4, s[96:99], s40 offen offset:1024  lds
  s_waitcnt lgkmcnt(2)
  v_add_f32 v112, v112, v10
  v_add_f32 v116, v116, v14
  v_add_f32 v114, v114, v12
  v_add_f32 v118, v118, v16
  v_add_f32 v113, v113, v11
  v_add_f32 v117, v117, v15
  v_add_f32 v115, v115, v13
  v_add_f32 v119, v119, v17
  v_cvt_pk_bf16_f32 v10, v112, v116
  v_cvt_pk_bf16_f32 v12, v114, v118
  v_cvt_pk_bf16_f32 v11, v113, v117
  v_cvt_pk_bf16_f32 v13, v115, v119
  v_mov_b32 v14, v10
  v_mov_b32 v15, v11
  v_mov_b32_dpp v10, v12 row_ror:8 row_mask:0xf bank_mask:0xc
  v_mov_b32_dpp v11, v13 row_ror:8 row_mask:0xf bank_mask:0xc
  v_mov_b32_dpp v12, v14 row_ror:8 row_mask:0xf bank_mask:0x3
  v_mov_b32_dpp v13, v15 row_ror:8 row_mask:0xf bank_mask:0x3
  v_mov_b32 v14, v10
  v_mov_b32 v15, v12
  v_mov_b32_dpp v10, v11 row_shr:4 row_mask:0xf bank_mask:0xa
  v_mov_b32_dpp v12, v13 row_shr:4 row_mask:0xf bank_mask:0xa
  v_mov_b32_dpp v11, v14 row_shl:4 row_mask:0xf bank_mask:0x5
  v_mov_b32_dpp v13, v15 row_shl:4 row_mask:0xf bank_mask:0x5
  s_add_u32 s39, s32, 917504
  buffer_store_dwordx4 v[10:13], v8, s[24:27], s39 offen sc1
  v_mfma_f32_16x16x32_bf16 v[120:123], v[36:39], v[128:131], 0
  v_mfma_f32_16x16x32_bf16 v[120:123], v[32:35], v[136:139], v[120:123]
  v_mfma_f32_16x16x32_bf16 v[120:123], v[40:43], v[144:147], v[120:123]
  v_mfma_f32_16x16x32_bf16 v[120:123], v[44:47], v[152:155], v[120:123]
  v_mfma_f32_16x16x32_bf16 v[124:127], v[44:47], v[156:159], 0
  v_mfma_f32_16x16x32_bf16 v[124:127], v[40:43], v[148:151], v[124:127]
  v_mfma_f32_16x16x32_bf16 v[124:127], v[32:35], v[140:143], v[124:127]
  v_mfma_f32_16x16x32_bf16 v[124:127], v[36:39], v[132:135], v[124:127]
  v_mfma_f32_16x16x32_bf16 v[124:127], v[52:55], v[164:167], v[124:127]
  v_mfma_f32_16x16x32_bf16 v[124:127], v[48:51], v[172:175], v[124:127]
  v_mfma_f32_16x16x32_bf16 v[124:127], v[56:59], v[180:183], v[124:127]
  v_mfma_f32_16x16x32_bf16 v[124:127], v[60:63], v[188:191], v[124:127]
  v_mfma_f32_16x16x32_bf16 v[120:123], v[60:63], v[184:187], v[120:123]
  v_mfma_f32_16x16x32_bf16 v[120:123], v[56:59], v[176:179], v[120:123]
  v_mfma_f32_16x16x32_bf16 v[120:123], v[48:51], v[168:171], v[120:123]
  ds_read_b128 v[84:87], v1 offset:33216
  v_mfma_f32_16x16x32_bf16 v[120:123], v[52:55], v[160:163], v[120:123]
  ds_read_b128 v[80:83], v1 offset:33232
  v_mfma_f32_16x16x32_bf16 v[120:123], v[68:71], v[192:195], v[120:123]
  ds_read_b128 v[44:47], v1 offset:33248
  v_mfma_f32_16x16x32_bf16 v[120:123], v[64:67], v[200:203], v[120:123]
  ds_read_b128 v[40:43], v1 offset:33264
  s_waitcnt lgkmcnt(5)
  v_mfma_f32_16x16x32_bf16 v[120:123], v[72:75], v[208:211], v[120:123]
  ds_read_b128 v[32:35], v2 offset:0
  s_waitcnt lgkmcnt(5)
  v_mfma_f32_16x16x32_bf16 v[120:123], v[76:79], v[216:219], v[120:123]
  ds_read_b128 v[36:39], v2 offset:16
  v_mfma_f32_16x16x32_bf16 v[124:127], v[76:79], v[220:223], v[124:127]
  ds_read_b128 v[60:63], v2 offset:32
  v_mfma_f32_16x16x32_bf16 v[124:127], v[72:75], v[212:215], v[124:127]
  ds_read_b128 v[56:59], v2 offset:48
  v_mfma_f32_16x16x32_bf16 v[124:127], v[64:67], v[204:207], v[124:127]
  ds_read_b128 v[48:51], v2 offset:64
  v_mfma_f32_16x16x32_bf16 v[124:127], v[68:71], v[196:199], v[124:127]
  ds_read_b128 v[52:55], v2 offset:80
  s_waitcnt lgkmcnt(8)
  v_mfma_f32_16x16x32_bf16 v[124:127], v[84:87], v[228:231], v[124:127]
  ds_read_b128 v[76:79], v2 offset:96
  v_mfma_f32_16x16x32_bf16 v[124:127], v[80:83], v[236:239], v[124:127]
  s_waitcnt lgkmcnt(7)
  v_mfma_f32_16x16x32_bf16 v[124:127], v[44:47], v[244:247], v[124:127]
  ds_read_b128 v[72:75], v2 offset:112
  v_mfma_f32_16x16x32_bf16 v[124:127], v[40:43], v[252:255], v[124:127]
  v_mfma_f32_16x16x32_bf16 v[120:123], v[40:43], v[248:251], v[120:123]
  ds_read_b128 v[64:67], v2 offset:128
  v_mfma_f32_16x16x32_bf16 v[120:123], v[44:47], v[240:243], v[120:123]
  v_mfma_f32_16x16x32_bf16 v[120:123], v[80:83], v[232:235], v[120:123]
  ds_read_b128 v[68:71], v2 offset:144
  v_mfma_f32_16x16x32_bf16 v[120:123], v[84:87], v[224:227], v[120:123]
  s_waitcnt vmcnt(4)
  s_barrier
  ds_read_b128 v[18:21], v7 offset:0
  ds_read_b128 v[22:25], v7 offset:4096
  ds_read_b128 v[40:43], v2 offset:160
  ds_read_b128 v[44:47], v2 offset:176
  s_add_u32 m0, s29, 33024
  s_add_u32 s40, s28, 424320
  buffer_load_dwordx4 v3, s[8:11], s40 offen  lds
  buffer_load_dwordx4 v4, s[96:99], s40 offen offset:1024  lds
  s_waitcnt lgkmcnt(2)
  v_add_f32 v120, v120, v18
  v_add_f32 v124, v124, v22
  v_add_f32 v122, v122, v20
  v_add_f32 v126, v126, v24
  v_add_f32 v121, v121, v19
  v_add_f32 v125, v125, v23
  v_add_f32 v123, v123, v21
  v_add_f32_e64 v127, v127, v25
  v_cvt_pk_bf16_f32 v18, v120, v124
  v_cvt_pk_bf16_f32 v20, v122, v126
  v_cvt_pk_bf16_f32 v19, v121, v125
  v_cvt_pk_bf16_f32 v21, v123, v127
  v_mov_b32 v22, v18
  v_mov_b32 v23, v19
  v_mov_b32_dpp v18, v20 row_ror:8 row_mask:0xf bank_mask:0xc
  v_mov_b32_dpp v19, v21 row_ror:8 row_mask:0xf bank_mask:0xc
  v_mov_b32_dpp v20, v22 row_ror:8 row_mask:0xf bank_mask:0x3
  v_mov_b32_dpp v21, v23 row_ror:8 row_mask:0xf bank_mask:0x3
  v_mov_b32 v22, v18
  v_mov_b32 v23, v20
  v_mov_b32_dpp v18, v19 row_shr:4 row_mask:0xf bank_mask:0xa
  v_mov_b32_dpp v20, v21 row_shr:4 row_mask:0xf bank_mask:0xa
  v_mov_b32_dpp v19, v22 row_shl:4 row_mask:0xf bank_mask:0x5
  v_mov_b32_dpp v21, v23 row_shl:4 row_mask:0xf bank_mask:0x5
  s_add_u32 s39, s32, 1032192
  buffer_store_dwordx4 v[18:21], v8, s[24:27], s39 offen sc1
  v_mfma_f32_16x16x32_bf16 v[88:91], v[32:35], v[128:131], 0
  v_mfma_f32_16x16x32_bf16 v[88:91], v[36:39], v[136:139], v[88:91]
  v_mfma_f32_16x16x32_bf16 v[88:91], v[60:63], v[144:147], v[88:91]
  v_mfma_f32_16x16x32_bf16 v[88:91], v[56:59], v[152:155], v[88:91]
  v_mfma_f32_16x16x32_bf16 v[92:95], v[56:59], v[156:159], 0
  v_mfma_f32_16x16x32_bf16 v[92:95], v[60:63], v[148:151], v[92:95]
  v_mfma_f32_16x16x32_bf16 v[92:95], v[36:39], v[140:143], v[92:95]
  v_mfma_f32_16x16x32_bf16 v[92:95], v[32:35], v[132:135], v[92:95]
  v_mfma_f32_16x16x32_bf16 v[92:95], v[48:51], v[164:167], v[92:95]
  v_mfma_f32_16x16x32_bf16 v[92:95], v[52:55], v[172:175], v[92:95]
  v_mfma_f32_16x16x32_bf16 v[92:95], v[76:79], v[180:183], v[92:95]
  v_mfma_f32_16x16x32_bf16 v[92:95], v[72:75], v[188:191], v[92:95]
  v_mfma_f32_16x16x32_bf16 v[88:91], v[72:75], v[184:187], v[88:91]
  v_mfma_f32_16x16x32_bf16 v[88:91], v[76:79], v[176:179], v[88:91]
  v_mfma_f32_16x16x32_bf16 v[88:91], v[52:55], v[168:171], v[88:91]
  ds_read_b128 v[80:83], v2 offset:192
  v_mfma_f32_16x16x32_bf16 v[88:91], v[48:51], v[160:163], v[88:91]
  ds_read_b128 v[84:87], v2 offset:208
  v_mfma_f32_16x16x32_bf16 v[88:91], v[64:67], v[192:195], v[88:91]
  ds_read_b128 v[56:59], v2 offset:224
  v_mfma_f32_16x16x32_bf16 v[88:91], v[68:71], v[200:203], v[88:91]
  ds_read_b128 v[60:63], v2 offset:240
  s_waitcnt lgkmcnt(5)
  v_mfma_f32_16x16x32_bf16 v[88:91], v[40:43], v[208:211], v[88:91]
  ds_read_b128 v[36:39], v2 offset:33024
  s_waitcnt lgkmcnt(5)
  v_mfma_f32_16x16x32_bf16 v[88:91], v[44:47], v[216:219], v[88:91]
  ds_read_b128 v[32:35], v2 offset:33040
  v_mfma_f32_16x16x32_bf16 v[92:95], v[44:47], v[220:223], v[92:95]
  ds_read_b128 v[72:75], v2 offset:33056
  v_mfma_f32_16x16x32_bf16 v[92:95], v[40:43], v[212:215], v[92:95]
  ds_read_b128 v[76:79], v2 offset:33072
  v_mfma_f32_16x16x32_bf16 v[92:95], v[68:71], v[204:207], v[92:95]
  ds_read_b128 v[52:55], v2 offset:33088
  v_mfma_f32_16x16x32_bf16 v[92:95], v[64:67], v[196:199], v[92:95]
  ds_read_b128 v[48:51], v2 offset:33104
  s_waitcnt lgkmcnt(8)
  v_mfma_f32_16x16x32_bf16 v[92:95], v[80:83], v[228:231], v[92:95]
  ds_read_b128 v[44:47], v2 offset:33120
  v_mfma_f32_16x16x32_bf16 v[92:95], v[84:87], v[236:239], v[92:95]
  s_waitcnt lgkmcnt(7)
  v_mfma_f32_16x16x32_bf16 v[92:95], v[56:59], v[244:247], v[92:95]
  ds_read_b128 v[40:43], v2 offset:33136
  v_mfma_f32_16x16x32_bf16 v[92:95], v[60:63], v[252:255], v[92:95]
  v_mfma_f32_16x16x32_bf16 v[88:91], v[60:63], v[248:251], v[88:91]
  ds_read_b128 v[68:71], v2 offset:33152
  v_mfma_f32_16x16x32_bf16 v[88:91], v[56:59], v[240:243], v[88:91]
  v_mfma_f32_16x16x32_bf16 v[88:91], v[84:87], v[232:235], v[88:91]
  ds_read_b128 v[64:67], v2 offset:33168
  v_mfma_f32_16x16x32_bf16 v[88:91], v[80:83], v[224:227], v[88:91]
  s_waitcnt vmcnt(4)
  s_barrier
  s_cmp_eq_u32 s34, 1
  s_cbranch_scc1 L_t15_0
  ds_read_b128 v[10:13], v7 offset:8192
  ds_read_b128 v[14:17], v7 offset:12288
  ds_read_b128 v[60:63], v2 offset:33184
  ds_read_b128 v[56:59], v2 offset:33200
  s_waitcnt lgkmcnt(2)
  s_nop 0
  v_add_f32 v88, v88, v10
  v_add_f32 v92, v92, v14
  v_add_f32 v90, v90, v12
  v_add_f32 v94, v94, v16
  v_add_f32 v89, v89, v11
  v_add_f32 v93, v93, v15
  v_add_f32 v91, v91, v13
  v_add_f32 v95, v95, v17
  v_cvt_pk_bf16_f32 v10, v88, v92
  v_cvt_pk_bf16_f32 v12, v90, v94
  v_cvt_pk_bf16_f32 v11, v89, v93
  v_cvt_pk_bf16_f32 v13, v91, v95
  v_mov_b32 v14, v10
  v_mov_b32 v15, v11
  v_mov_b32_dpp v10, v12 row_ror:8 row_mask:0xf bank_mask:0xc
  v_mov_b32_dpp v11, v13 row_ror:8 row_mask:0xf bank_mask:0xc
  v_mov_b32_dpp v12, v14 row_ror:8 row_mask:0xf bank_mask:0x3
  v_mov_b32_dpp v13, v15 row_ror:8 row_mask:0xf bank_mask:0x3
  v_mov_b32 v14, v10
  v_mov_b32 v15, v12
  v_mov_b32_dpp v10, v11 row_shr:4 row_mask:0xf bank_mask:0xa
  v_mov_b32_dpp v12, v13 row_shr:4 row_mask:0xf bank_mask:0xa
  v_mov_b32_dpp v11, v14 row_shl:4 row_mask:0xf bank_mask:0x5
  v_mov_b32_dpp v13, v15 row_shl:4 row_mask:0xf bank_mask:0x5
  s_add_u32 s39, s32, 1146880
  buffer_store_dwordx4 v[10:13], v8, s[24:27], s39 offen sc1
  v_mfma_f32_16x16x32_bf16 v[96:99], v[36:39], v[128:131], 0
  v_mfma_f32_16x16x32_bf16 v[96:99], v[32:35], v[136:139], v[96:99]
  v_mfma_f32_16x16x32_bf16 v[96:99], v[72:75], v[144:147], v[96:99]
  v_mfma_f32_16x16x32_bf16 v[96:99], v[76:79], v[152:155], v[96:99]
  v_mfma_f32_16x16x32_bf16 v[100:103], v[76:79], v[156:159], 0
  v_mfma_f32_16x16x32_bf16 v[100:103], v[72:75], v[148:151], v[100:103]
  v_mfma_f32_16x16x32_bf16 v[100:103], v[32:35], v[140:143], v[100:103]
  v_mfma_f32_16x16x32_bf16 v[100:103], v[36:39], v[132:135], v[100:103]
  v_mfma_f32_16x16x32_bf16 v[100:103], v[52:55], v[164:167], v[100:103]
  v_mfma_f32_16x16x32_bf16 v[100:103], v[48:51], v[172:175], v[100:103]
  v_mfma_f32_16x16x32_bf16 v[100:103], v[44:47], v[180:183], v[100:103]
  v_mfma_f32_16x16x32_bf16 v[100:103], v[40:43], v[188:191], v[100:103]
  v_mfma_f32_16x16x32_bf16 v[96:99], v[40:43], v[184:187], v[96:99]
  v_mfma_f32_16x16x32_bf16 v[96:99], v[44:47], v[176:179], v[96:99]
  v_mfma_f32_16x16x32_bf16 v[96:99], v[48:51], v[168:171], v[96:99]
  ds_read_b128 v[84:87], v2 offset:33216
  v_mfma_f32_16x16x32_bf16 v[96:99], v[52:55], v[160:163], v[96:99]
  ds_read_b128 v[80:83], v2 offset:33232
  v_mfma_f32_16x16x32_bf16 v[96:99], v[68:71], v[192:195], v[96:99]
  ds_read_b128 v[76:79], v2 offset:33248
  v_mfma_f32_16x16x32_bf16 v[96:99], v[64:67], v[200:203], v[96:99]
  ds_read_b128 v[72:75], v2 offset:33264
  s_waitcnt lgkmcnt(5)
  v_mfma_f32_16x16x32_bf16 v[96:99], v[60:63], v[208:211], v[96:99]
  ds_read_b128 v[32:35], v1 offset:0
  s_waitcnt lgkmcnt(5)
  v_mfma_f32_16x16x32_bf16 v[96:99], v[56:59], v[216:219], v[96:99]
  ds_read_b128 v[36:39], v1 offset:16
  v_mfma_f32_16x16x32_bf16 v[100:103], v[56:59], v[220:223], v[100:103]
  ds_read_b128 v[40:43], v1 offset:32
  v_mfma_f32_16x16x32_bf16 v[100:103], v[60:63], v[212:215], v[100:103]
  ds_read_b128 v[44:47], v1 offset:48
  v_mfma_f32_16x16x32_bf16 v[100:103], v[64:67], v[204:207], v[100:103]
  ds_read_b128 v[48:51], v1 offset:64
  v_mfma_f32_16x16x32_bf16 v[100:103], v[68:71], v[196:199], v[100:103]
  ds_read_b128 v[52:55], v1 offset:80
  s_waitcnt lgkmcnt(8)
  v_mfma_f32_16x16x32_bf16 v[100:103], v[84:87], v[228:231], v[100:103]
  ds_read_b128 v[56:59], v1 offset:96
  v_mfma_f32_16x16x32_bf16 v[100:103], v[80:83], v[236:239], v[100:103]
  s_waitcnt lgkmcnt(7)
  v_mfma_f32_16x16x32_bf16 v[100:103], v[76:79], v[244:247], v[100:103]
  ds_read_b128 v[60:63], v1 offset:112
  v_mfma_f32_16x16x32_bf16 v[100:103], v[72:75], v[252:255], v[100:103]
  v_mfma_f32_16x16x32_bf16 v[96:99], v[72:75], v[248:251], v[96:99]
  ds_read_b128 v[64:67], v1 offset:128
  v_mfma_f32_16x16x32_bf16 v[96:99], v[76:79], v[240:243], v[96:99]
  v_mfma_f32_16x16x32_bf16 v[96:99], v[80:83], v[232:235], v[96:99]
  ds_read_b128 v[68:71], v1 offset:144
  v_mfma_f32_16x16x32_bf16 v[96:99], v[84:87], v[224:227], v[96:99]
  s_waitcnt vmcnt(2)
  s_barrier
  ds_read_b128 v[18:21], v7 offset:16384
  ds_read_b128 v[22:25], v7 offset:20480
  ds_read_b128 v[72:75], v1 offset:160
  ds_read_b128 v[76:79], v1 offset:176
  s_waitcnt lgkmcnt(2)
  s_nop 0
  v_add_f32 v96, v96, v18
  v_add_f32 v100, v100, v22
  v_add_f32 v98, v98, v20
  v_add_f32 v102, v102, v24
  v_add_f32 v97, v97, v19
  v_add_f32 v101, v101, v23
  v_add_f32 v99, v99, v21
  v_add_f32 v103, v103, v25
  v_cvt_pk_bf16_f32 v18, v96, v100
  v_cvt_pk_bf16_f32 v20, v98, v102
  v_cvt_pk_bf16_f32 v19, v97, v101
  v_cvt_pk_bf16_f32 v21, v99, v103
  v_mov_b32 v22, v18
  v_mov_b32 v23, v19
  v_mov_b32_dpp v18, v20 row_ror:8 row_mask:0xf bank_mask:0xc
  v_mov_b32_dpp v19, v21 row_ror:8 row_mask:0xf bank_mask:0xc
  v_mov_b32_dpp v20, v22 row_ror:8 row_mask:0xf bank_mask:0x3
  v_mov_b32_dpp v21, v23 row_ror:8 row_mask:0xf bank_mask:0x3
  v_mov_b32 v22, v18
  v_mov_b32 v23, v20
  v_mov_b32_dpp v18, v19 row_shr:4 row_mask:0xf bank_mask:0xa
  v_mov_b32_dpp v20, v21 row_shr:4 row_mask:0xf bank_mask:0xa
  v_mov_b32_dpp v19, v22 row_shl:4 row_mask:0xf bank_mask:0x5
  v_mov_b32_dpp v21, v23 row_shl:4 row_mask:0xf bank_mask:0x5
  s_add_u32 s39, s32, 1261568
  buffer_store_dwordx4 v[18:21], v8, s[24:27], s39 offen sc1
  v_mfma_f32_16x16x32_bf16 v[104:107], v[32:35], v[128:131], 0
  v_mfma_f32_16x16x32_bf16 v[104:107], v[36:39], v[136:139], v[104:107]
  v_mfma_f32_16x16x32_bf16 v[104:107], v[40:43], v[144:147], v[104:107]
  v_mfma_f32_16x16x32_bf16 v[104:107], v[44:47], v[152:155], v[104:107]
  v_mfma_f32_16x16x32_bf16 v[108:111], v[44:47], v[156:159], 0
  v_mfma_f32_16x16x32_bf16 v[108:111], v[40:43], v[148:151], v[108:111]
  v_mfma_f32_16x16x32_bf16 v[108:111], v[36:39], v[140:143], v[108:111]
  v_mfma_f32_16x16x32_bf16 v[108:111], v[32:35], v[132:135], v[108:111]
  v_mfma_f32_16x16x32_bf16 v[108:111], v[48:51], v[164:167], v[108:111]
  v_mfma_f32_16x16x32_bf16 v[108:111], v[52:55], v[172:175], v[108:111]
  v_mfma_f32_16x16x32_bf16 v[108:111], v[56:59], v[180:183], v[108:111]
  v_mfma_f32_16x16x32_bf16 v[108:111], v[60:63], v[188:191], v[108:111]
  v_mfma_f32_16x16x32_bf16 v[104:107], v[60:63], v[184:187], v[104:107]
  v_mfma_f32_16x16x32_bf16 v[104:107], v[56:59], v[176:179], v[104:107]
  v_mfma_f32_16x16x32_bf16 v[104:107], v[52:55], v[168:171], v[104:107]
  ds_read_b128 v[80:83], v1 offset:192
  v_mfma_f32_16x16x32_bf16 v[104:107], v[48:51], v[160:163], v[104:107]
  ds_read_b128 v[84:87], v1 offset:208
  v_mfma_f32_16x16x32_bf16 v[104:107], v[64:67], v[192:195], v[104:107]
  ds_read_b128 v[44:47], v1 offset:224
  v_mfma_f32_16x16x32_bf16 v[104:107], v[68:71], v[200:203], v[104:107]
  ds_read_b128 v[40:43], v1 offset:240
  s_waitcnt lgkmcnt(5)
  v_mfma_f32_16x16x32_bf16 v[104:107], v[72:75], v[208:211], v[104:107]
  ds_read_b128 v[36:39], v1 offset:33024
  s_waitcnt lgkmcnt(5)
  v_mfma_f32_16x16x32_bf16 v[104:107], v[76:79], v[216:219], v[104:107]
  ds_read_b128 v[32:35], v1 offset:33040
  v_mfma_f32_16x16x32_bf16 v[108:111], v[76:79], v[220:223], v[108:111]
  ds_read_b128 v[60:63], v1 offset:33056
  v_mfma_f32_16x16x32_bf16 v[108:111], v[72:75], v[212:215], v[108:111]
  ds_read_b128 v[56:59], v1 offset:33072
  v_mfma_f32_16x16x32_bf16 v[108:111], v[68:71], v[204:207], v[108:111]
  ds_read_b128 v[52:55], v1 offset:33088
  v_mfma_f32_16x16x32_bf16 v[108:111], v[64:67], v[196:199], v[108:111]
  ds_read_b128 v[48:51], v1 offset:33104
  s_waitcnt lgkmcnt(8)
  v_mfma_f32_16x16x32_bf16 v[108:111], v[80:83], v[228:231], v[108:111]
  ds_read_b128 v[76:79], v1 offset:33120
  v_mfma_f32_16x16x32_bf16 v[108:111], v[84:87], v[236:239], v[108:111]
  s_waitcnt lgkmcnt(7)
  v_mfma_f32_16x16x32_bf16 v[108:111], v[44:47], v[244:247], v[108:111]
  ds_read_b128 v[72:75], v1 offset:33136
  v_mfma_f32_16x16x32_bf16 v[108:111], v[40:43], v[252:255], v[108:111]
  v_mfma_f32_16x16x32_bf16 v[104:107], v[40:43], v[248:251], v[104:107]
  ds_read_b128 v[68:71], v1 offset:33152
  v_mfma_f32_16x16x32_bf16 v[104:107], v[44:47], v[240:243], v[104:107]
  v_mfma_f32_16x16x32_bf16 v[104:107], v[84:87], v[232:235], v[104:107]
  ds_read_b128 v[64:67], v1 offset:33168
  v_mfma_f32_16x16x32_bf16 v[104:107], v[80:83], v[224:227], v[104:107]
  s_barrier
  ds_read_b128 v[10:13], v7 offset:0
  ds_read_b128 v[14:17], v7 offset:4096
  ds_read_b128 v[40:43], v1 offset:33184
  ds_read_b128 v[44:47], v1 offset:33200
  s_waitcnt lgkmcnt(2)
  s_nop 1
  v_add_f32 v104, v104, v10
  v_add_f32 v108, v108, v14
  v_add_f32 v106, v106, v12
  v_add_f32 v110, v110, v16
  v_add_f32 v105, v105, v11
  v_add_f32 v109, v109, v15
  v_add_f32 v107, v107, v13
  v_add_f32_e64 v111, v111, v17
  v_cvt_pk_bf16_f32 v10, v104, v108
  v_cvt_pk_bf16_f32 v12, v106, v110
  v_cvt_pk_bf16_f32 v11, v105, v109
  v_cvt_pk_bf16_f32 v13, v107, v111
  v_mov_b32 v14, v10
  v_mov_b32 v15, v11
  v_mov_b32_dpp v10, v12 row_ror:8 row_mask:0xf bank_mask:0xc
  v_mov_b32_dpp v11, v13 row_ror:8 row_mask:0xf bank_mask:0xc
  v_mov_b32_dpp v12, v14 row_ror:8 row_mask:0xf bank_mask:0x3
  v_mov_b32_dpp v13, v15 row_ror:8 row_mask:0xf bank_mask:0x3
  v_mov_b32 v14, v10
  v_mov_b32 v15, v12
  v_mov_b32_dpp v10, v11 row_shr:4 row_mask:0xf bank_mask:0xa
  v_mov_b32_dpp v12, v13 row_shr:4 row_mask:0xf bank_mask:0xa
  v_mov_b32_dpp v11, v14 row_shl:4 row_mask:0xf bank_mask:0x5
  v_mov_b32_dpp v13, v15 row_shl:4 row_mask:0xf bank_mask:0x5
  s_add_u32 s39, s32, 1376256
  buffer_store_dwordx4 v[10:13], v8, s[24:27], s39 offen sc1
  v_mfma_f32_16x16x32_bf16 v[112:115], v[36:39], v[128:131], 0
  v_mfma_f32_16x16x32_bf16 v[112:115], v[32:35], v[136:139], v[112:115]
  v_mfma_f32_16x16x32_bf16 v[112:115], v[60:63], v[144:147], v[112:115]
  v_mfma_f32_16x16x32_bf16 v[112:115], v[56:59], v[152:155], v[112:115]
  v_mfma_f32_16x16x32_bf16 v[116:119], v[56:59], v[156:159], 0
  v_mfma_f32_16x16x32_bf16 v[116:119], v[60:63], v[148:151], v[116:119]
  v_mfma_f32_16x16x32_bf16 v[116:119], v[32:35], v[140:143], v[116:119]
  v_mfma_f32_16x16x32_bf16 v[116:119], v[36:39], v[132:135], v[116:119]
  v_mfma_f32_16x16x32_bf16 v[116:119], v[52:55], v[164:167], v[116:119]
  v_mfma_f32_16x16x32_bf16 v[116:119], v[48:51], v[172:175], v[116:119]
  v_mfma_f32_16x16x32_bf16 v[116:119], v[76:79], v[180:183], v[116:119]
  v_mfma_f32_16x16x32_bf16 v[116:119], v[72:75], v[188:191], v[116:119]
  v_mfma_f32_16x16x32_bf16 v[112:115], v[72:75], v[184:187], v[112:115]
  v_mfma_f32_16x16x32_bf16 v[112:115], v[76:79], v[176:179], v[112:115]
  v_mfma_f32_16x16x32_bf16 v[112:115], v[48:51], v[168:171], v[112:115]
  ds_read_b128 v[84:87], v1 offset:33216
  v_mfma_f32_16x16x32_bf16 v[112:115], v[52:55], v[160:163], v[112:115]
  ds_read_b128 v[80:83], v1 offset:33232
  s_barrier
  ds_read_b128 v[18:21], v7 offset:8192
  ds_read_b128 v[22:25], v7 offset:12288
  v_mfma_f32_16x16x32_bf16 v[112:115], v[68:71], v[192:195], v[112:115]
  ds_read_b128 v[56:59], v1 offset:33248
  v_mfma_f32_16x16x32_bf16 v[112:115], v[64:67], v[200:203], v[112:115]
  ds_read_b128 v[60:63], v1 offset:33264
  s_waitcnt lgkmcnt(7)
  v_mfma_f32_16x16x32_bf16 v[112:115], v[40:43], v[208:211], v[112:115]
  s_waitcnt lgkmcnt(6)
  v_mfma_f32_16x16x32_bf16 v[112:115], v[44:47], v[216:219], v[112:115]
  v_mfma_f32_16x16x32_bf16 v[116:119], v[44:47], v[220:223], v[116:119]
  v_mfma_f32_16x16x32_bf16 v[116:119], v[40:43], v[212:215], v[116:119]
  v_mfma_f32_16x16x32_bf16 v[116:119], v[64:67], v[204:207], v[116:119]
  v_mfma_f32_16x16x32_bf16 v[116:119], v[68:71], v[196:199], v[116:119]
  s_waitcnt lgkmcnt(5)
  v_mfma_f32_16x16x32_bf16 v[116:119], v[84:87], v[228:231], v[116:119]
  s_waitcnt lgkmcnt(4)
  v_mfma_f32_16x16x32_bf16 v[116:119], v[80:83], v[236:239], v[116:119]
  s_waitcnt lgkmcnt(1)
  v_mfma_f32_16x16x32_bf16 v[116:119], v[56:59], v[244:247], v[116:119]
  s_waitcnt lgkmcnt(0)
  v_mfma_f32_16x16x32_bf16 v[116:119], v[60:63], v[252:255], v[116:119]
  v_mfma_f32_16x16x32_bf16 v[112:115], v[60:63], v[248:251], v[112:115]
  v_mfma_f32_16x16x32_bf16 v[112:115], v[56:59], v[240:243], v[112:115]
  v_mfma_f32_16x16x32_bf16 v[112:115], v[80:83], v[232:235], v[112:115]
  v_mfma_f32_16x16x32_bf16 v[112:115], v[84:87], v[224:227], v[112:115]
  s_nop 7
  v_add_f32 v112, v112, v18
  v_add_f32 v116, v116, v22
  v_add_f32 v114, v114, v20
  v_add_f32 v118, v118, v24
  v_add_f32 v113, v113, v19
  v_add_f32 v117, v117, v23
  v_add_f32 v115, v115, v21
  v_add_f32 v119, v119, v25
  v_cvt_pk_bf16_f32 v18, v112, v116
  v_cvt_pk_bf16_f32 v20, v114, v118
  v_cvt_pk_bf16_f32 v19, v113, v117
  v_cvt_pk_bf16_f32 v21, v115, v119
  v_mov_b32 v22, v18
  v_mov_b32 v23, v19
  v_mov_b32_dpp v18, v20 row_ror:8 row_mask:0xf bank_mask:0xc
  v_mov_b32_dpp v19, v21 row_ror:8 row_mask:0xf bank_mask:0xc
  v_mov_b32_dpp v20, v22 row_ror:8 row_mask:0xf bank_mask:0x3
  v_mov_b32_dpp v21, v23 row_ror:8 row_mask:0xf bank_mask:0x3
  v_mov_b32 v22, v18
  v_mov_b32 v23, v20
  v_mov_b32_dpp v18, v19 row_shr:4 row_mask:0xf bank_mask:0xa
  v_mov_b32_dpp v20, v21 row_shr:4 row_mask:0xf bank_mask:0xa
  v_mov_b32_dpp v19, v22 row_shl:4 row_mask:0xf bank_mask:0x5
  v_mov_b32_dpp v21, v23 row_shl:4 row_mask:0xf bank_mask:0x5
  s_add_u32 s39, s32, 1490944
  buffer_store_dwordx4 v[18:21], v8, s[24:27], s39 offen sc1
  s_endpgm
.p2align 3
L_t15_0:
  ds_read_b128 v[10:13], v7 offset:8192
  ds_read_b128 v[14:17], v7 offset:12288
  ds_read_b128 v[60:63], v2 offset:33184
  ds_read_b128 v[56:59], v2 offset:33200
  s_add_u32 m0, s29, 66048
  s_add_u32 s40, s28, 456960
  buffer_load_dwordx4 v3, s[8:11], s40 offen  lds
  buffer_load_dwordx4 v4, s[96:99], s40 offen offset:1024  lds
  s_waitcnt lgkmcnt(2)
  v_add_f32 v88, v88, v10
  v_add_f32 v92, v92, v14
  v_add_f32 v90, v90, v12
  v_add_f32 v94, v94, v16
  v_add_f32 v89, v89, v11
  v_add_f32 v93, v93, v15
  v_add_f32 v91, v91, v13
  v_add_f32_e64 v95, v95, v17
  v_cvt_pk_bf16_f32 v10, v88, v92
  v_cvt_pk_bf16_f32 v12, v90, v94
  v_cvt_pk_bf16_f32 v11, v89, v93
  v_cvt_pk_bf16_f32 v13, v91, v95
  v_mov_b32 v14, v10
  v_mov_b32 v15, v11
  v_mov_b32_dpp v10, v12 row_ror:8 row_mask:0xf bank_mask:0xc
  v_mov_b32_dpp v11, v13 row_ror:8 row_mask:0xf bank_mask:0xc
  v_mov_b32_dpp v12, v14 row_ror:8 row_mask:0xf bank_mask:0x3
  v_mov_b32_dpp v13, v15 row_ror:8 row_mask:0xf bank_mask:0x3
  v_mov_b32 v14, v10
  v_mov_b32 v15, v12
  v_mov_b32_dpp v10, v11 row_shr:4 row_mask:0xf bank_mask:0xa
  v_mov_b32_dpp v12, v13 row_shr:4 row_mask:0xf bank_mask:0xa
  v_mov_b32_dpp v11, v14 row_shl:4 row_mask:0xf bank_mask:0x5
  v_mov_b32_dpp v13, v15 row_shl:4 row_mask:0xf bank_mask:0x5
  s_add_u32 s39, s32, 1146880
  buffer_store_dwordx4 v[10:13], v8, s[24:27], s39 offen sc1
  v_mfma_f32_16x16x32_bf16 v[96:99], v[36:39], v[128:131], 0
  v_mfma_f32_16x16x32_bf16 v[96:99], v[32:35], v[136:139], v[96:99]
  v_mfma_f32_16x16x32_bf16 v[96:99], v[72:75], v[144:147], v[96:99]
  v_mfma_f32_16x16x32_bf16 v[96:99], v[76:79], v[152:155], v[96:99]
  v_mfma_f32_16x16x32_bf16 v[100:103], v[76:79], v[156:159], 0
  v_mfma_f32_16x16x32_bf16 v[100:103], v[72:75], v[148:151], v[100:103]
  v_mfma_f32_16x16x32_bf16 v[100:103], v[32:35], v[140:143], v[100:103]
  v_mfma_f32_16x16x32_bf16 v[100:103], v[36:39], v[132:135], v[100:103]
  v_mfma_f32_16x16x32_bf16 v[100:103], v[52:55], v[164:167], v[100:103]
  v_mfma_f32_16x16x32_bf16 v[100:103], v[48:51], v[172:175], v[100:103]
  v_mfma_f32_16x16x32_bf16 v[100:103], v[44:47], v[180:183], v[100:103]
  v_mfma_f32_16x16x32_bf16 v[100:103], v[40:43], v[188:191], v[100:103]
  v_mfma_f32_16x16x32_bf16 v[96:99], v[40:43], v[184:187], v[96:99]
  v_mfma_f32_16x16x32_bf16 v[96:99], v[44:47], v[176:179], v[96:99]
  v_mfma_f32_16x16x32_bf16 v[96:99], v[48:51], v[168:171], v[96:99]
  ds_read_b128 v[84:87], v2 offset:33216
  v_mfma_f32_16x16x32_bf16 v[96:99], v[52:55], v[160:163], v[96:99]
  ds_read_b128 v[80:83], v2 offset:33232
  v_mfma_f32_16x16x32_bf16 v[96:99], v[68:71], v[192:195], v[96:99]
  ds_read_b128 v[76:79], v2 offset:33248
  v_mfma_f32_16x16x32_bf16 v[96:99], v[64:67], v[200:203], v[96:99]
  ds_read_b128 v[72:75], v2 offset:33264
  s_waitcnt lgkmcnt(5)
  v_mfma_f32_16x16x32_bf16 v[96:99], v[60:63], v[208:211], v[96:99]
  ds_read_b128 v[32:35], v1 offset:0
  s_waitcnt lgkmcnt(5)
  v_mfma_f32_16x16x32_bf16 v[96:99], v[56:59], v[216:219], v[96:99]
  ds_read_b128 v[36:39], v1 offset:16
  v_mfma_f32_16x16x32_bf16 v[100:103], v[56:59], v[220:223], v[100:103]
  ds_read_b128 v[40:43], v1 offset:32
  v_mfma_f32_16x16x32_bf16 v[100:103], v[60:63], v[212:215], v[100:103]
  ds_read_b128 v[44:47], v1 offset:48
  v_mfma_f32_16x16x32_bf16 v[100:103], v[64:67], v[204:207], v[100:103]
  ds_read_b128 v[48:51], v1 offset:64
  v_mfma_f32_16x16x32_bf16 v[100:103], v[68:71], v[196:199], v[100:103]
  ds_read_b128 v[52:55], v1 offset:80
  s_waitcnt lgkmcnt(8)
  v_mfma_f32_16x16x32_bf16 v[100:103], v[84:87], v[228:231], v[100:103]
  ds_read_b128 v[56:59], v1 offset:96
  v_mfma_f32_16x16x32_bf16 v[100:103], v[80:83], v[236:239], v[100:103]
  s_waitcnt lgkmcnt(7)
  v_mfma_f32_16x16x32_bf16 v[100:103], v[76:79], v[244:247], v[100:103]
  ds_read_b128 v[60:63], v1 offset:112
  v_mfma_f32_16x16x32_bf16 v[100:103], v[72:75], v[252:255], v[100:103]
  v_mfma_f32_16x16x32_bf16 v[96:99], v[72:75], v[248:251], v[96:99]
  ds_read_b128 v[64:67], v1 offset:128
  v_mfma_f32_16x16x32_bf16 v[96:99], v[76:79], v[240:243], v[96:99]
  v_mfma_f32_16x16x32_bf16 v[96:99], v[80:83], v[232:235], v[96:99]
  ds_read_b128 v[68:71], v1 offset:144
  v_mfma_f32_16x16x32_bf16 v[96:99], v[84:87], v[224:227], v[96:99]
  s_waitcnt vmcnt(4)
  s_barrier
  ds_read_b128 v[18:21], v7 offset:16384
  ds_read_b128 v[22:25], v7 offset:20480
  ds_read_b128 v[72:75], v1 offset:160
  ds_read_b128 v[76:79], v1 offset:176
  s_waitcnt lgkmcnt(2)
  s_nop 0
  v_add_f32 v96, v96, v18
  v_add_f32 v100, v100, v22
  v_add_f32 v98, v98, v20
  v_add_f32 v102, v102, v24
  v_add_f32 v97, v97, v19
  v_add_f32 v101, v101, v23
  v_add_f32 v99, v99, v21
  v_add_f32 v103, v103, v25
  v_cvt_pk_bf16_f32 v18, v96, v100
  v_cvt_pk_bf16_f32 v20, v98, v102
  v_cvt_pk_bf16_f32 v19, v97, v101
  v_cvt_pk_bf16_f32 v21, v99, v103
  v_mov_b32 v22, v18
  v_mov_b32 v23, v19
  v_mov_b32_dpp v18, v20 row_ror:8 row_mask:0xf bank_mask:0xc
  v_mov_b32_dpp v19, v21 row_ror:8 row_mask:0xf bank_mask:0xc
  v_mov_b32_dpp v20, v22 row_ror:8 row_mask:0xf bank_mask:0x3
  v_mov_b32_dpp v21, v23 row_ror:8 row_mask:0xf bank_mask:0x3
  v_mov_b32 v22, v18
  v_mov_b32 v23, v20
  v_mov_b32_dpp v18, v19 row_shr:4 row_mask:0xf bank_mask:0xa
  v_mov_b32_dpp v20, v21 row_shr:4 row_mask:0xf bank_mask:0xa
  v_mov_b32_dpp v19, v22 row_shl:4 row_mask:0xf bank_mask:0x5
  v_mov_b32_dpp v21, v23 row_shl:4 row_mask:0xf bank_mask:0x5
  s_add_u32 s39, s32, 1261568
  buffer_store_dwordx4 v[18:21], v8, s[24:27], s39 offen sc1
  v_mfma_f32_16x16x32_bf16 v[104:107], v[32:35], v[128:131], 0
  v_mfma_f32_16x16x32_bf16 v[104:107], v[36:39], v[136:139], v[104:107]
  v_mfma_f32_16x16x32_bf16 v[104:107], v[40:43], v[144:147], v[104:107]
  v_mfma_f32_16x16x32_bf16 v[104:107], v[44:47], v[152:155], v[104:107]
  v_mfma_f32_16x16x32_bf16 v[108:111], v[44:47], v[156:159], 0
  v_mfma_f32_16x16x32_bf16 v[108:111], v[40:43], v[148:151], v[108:111]
  v_mfma_f32_16x16x32_bf16 v[108:111], v[36:39], v[140:143], v[108:111]
  v_mfma_f32_16x16x32_bf16 v[108:111], v[32:35], v[132:135], v[108:111]
  v_mfma_f32_16x16x32_bf16 v[108:111], v[48:51], v[164:167], v[108:111]
  v_mfma_f32_16x16x32_bf16 v[108:111], v[52:55], v[172:175], v[108:111]
  v_mfma_f32_16x16x32_bf16 v[108:111], v[56:59], v[180:183], v[108:111]
  v_mfma_f32_16x16x32_bf16 v[108:111], v[60:63], v[188:191], v[108:111]
  v_mfma_f32_16x16x32_bf16 v[104:107], v[60:63], v[184:187], v[104:107]
  v_mfma_f32_16x16x32_bf16 v[104:107], v[56:59], v[176:179], v[104:107]
  v_mfma_f32_16x16x32_bf16 v[104:107], v[52:55], v[168:171], v[104:107]
  ds_read_b128 v[80:83], v1 offset:192
  v_mfma_f32_16x16x32_bf16 v[104:107], v[48:51], v[160:163], v[104:107]
  ds_read_b128 v[84:87], v1 offset:208
  v_mfma_f32_16x16x32_bf16 v[104:107], v[64:67], v[192:195], v[104:107]
  ds_read_b128 v[44:47], v1 offset:224
  v_mfma_f32_16x16x32_bf16 v[104:107], v[68:71], v[200:203], v[104:107]
  ds_read_b128 v[40:43], v1 offset:240
  s_waitcnt lgkmcnt(5)
  v_mfma_f32_16x16x32_bf16 v[104:107], v[72:75], v[208:211], v[104:107]
  ds_read_b128 v[36:39], v1 offset:33024
  s_waitcnt lgkmcnt(5)
  v_mfma_f32_16x16x32_bf16 v[104:107], v[76:79], v[216:219], v[104:107]
  ds_read_b128 v[32:35], v1 offset:33040
  v_mfma_f32_16x16x32_bf16 v[108:111], v[76:79], v[220:223], v[108:111]
  ds_read_b128 v[60:63], v1 offset:33056
  v_mfma_f32_16x16x32_bf16 v[108:111], v[72:75], v[212:215], v[108:111]
  ds_read_b128 v[56:59], v1 offset:33072
  v_mfma_f32_16x16x32_bf16 v[108:111], v[68:71], v[204:207], v[108:111]
  ds_read_b128 v[52:55], v1 offset:33088
  v_mfma_f32_16x16x32_bf16 v[108:111], v[64:67], v[196:199], v[108:111]
  ds_read_b128 v[48:51], v1 offset:33104
  s_waitcnt lgkmcnt(8)
  v_mfma_f32_16x16x32_bf16 v[108:111], v[80:83], v[228:231], v[108:111]
  ds_read_b128 v[76:79], v1 offset:33120
  v_mfma_f32_16x16x32_bf16 v[108:111], v[84:87], v[236:239], v[108:111]
  s_waitcnt lgkmcnt(7)
  v_mfma_f32_16x16x32_bf16 v[108:111], v[44:47], v[244:247], v[108:111]
  ds_read_b128 v[72:75], v1 offset:33136
  v_mfma_f32_16x16x32_bf16 v[108:111], v[40:43], v[252:255], v[108:111]
  v_mfma_f32_16x16x32_bf16 v[104:107], v[40:43], v[248:251], v[104:107]
  ds_read_b128 v[68:71], v1 offset:33152
  v_mfma_f32_16x16x32_bf16 v[104:107], v[44:47], v[240:243], v[104:107]
  v_mfma_f32_16x16x32_bf16 v[104:107], v[84:87], v[232:235], v[104:107]
  ds_read_b128 v[64:67], v1 offset:33168
  v_mfma_f32_16x16x32_bf16 v[104:107], v[80:83], v[224:227], v[104:107]
  s_waitcnt vmcnt(2)
  s_barrier
  ds_read_b128 v[10:13], v7 offset:0
  ds_read_b128 v[14:17], v7 offset:4096
  ds_read_b128 v[40:43], v1 offset:33184
  ds_read_b128 v[44:47], v1 offset:33200
  s_waitcnt lgkmcnt(2)
  s_nop 0
  v_add_f32 v104, v104, v10
  v_add_f32 v108, v108, v14
  v_add_f32 v106, v106, v12
  v_add_f32 v110, v110, v16
  v_add_f32 v105, v105, v11
  v_add_f32 v109, v109, v15
  v_add_f32 v107, v107, v13
  v_add_f32 v111, v111, v17
  v_cvt_pk_bf16_f32 v10, v104, v108
  v_cvt_pk_bf16_f32 v12, v106, v110
  v_cvt_pk_bf16_f32 v11, v105, v109
  v_cvt_pk_bf16_f32 v13, v107, v111
  v_mov_b32 v14, v10
  v_mov_b32 v15, v11
  v_mov_b32_dpp v10, v12 row_ror:8 row_mask:0xf bank_mask:0xc
  v_mov_b32_dpp v11, v13 row_ror:8 row_mask:0xf bank_mask:0xc
  v_mov_b32_dpp v12, v14 row_ror:8 row_mask:0xf bank_mask:0x3
  v_mov_b32_dpp v13, v15 row_ror:8 row_mask:0xf bank_mask:0x3
  v_mov_b32 v14, v10
  v_mov_b32 v15, v12
  v_mov_b32_dpp v10, v11 row_shr:4 row_mask:0xf bank_mask:0xa
  v_mov_b32_dpp v12, v13 row_shr:4 row_mask:0xf bank_mask:0xa
  v_mov_b32_dpp v11, v14 row_shl:4 row_mask:0xf bank_mask:0x5
  v_mov_b32_dpp v13, v15 row_shl:4 row_mask:0xf bank_mask:0x5
  s_add_u32 s39, s32, 1376256
  buffer_store_dwordx4 v[10:13], v8, s[24:27], s39 offen sc1
  v_mfma_f32_16x16x32_bf16 v[112:115], v[36:39], v[128:131], 0
  v_mfma_f32_16x16x32_bf16 v[112:115], v[32:35], v[136:139], v[112:115]
  v_mfma_f32_16x16x32_bf16 v[112:115], v[60:63], v[144:147], v[112:115]
  v_mfma_f32_16x16x32_bf16 v[112:115], v[56:59], v[152:155], v[112:115]
  v_mfma_f32_16x16x32_bf16 v[116:119], v[56:59], v[156:159], 0
  v_mfma_f32_16x16x32_bf16 v[116:119], v[60:63], v[148:151], v[116:119]
  v_mfma_f32_16x16x32_bf16 v[116:119], v[32:35], v[140:143], v[116:119]
  v_mfma_f32_16x16x32_bf16 v[116:119], v[36:39], v[132:135], v[116:119]
  v_mfma_f32_16x16x32_bf16 v[116:119], v[52:55], v[164:167], v[116:119]
  v_mfma_f32_16x16x32_bf16 v[116:119], v[48:51], v[172:175], v[116:119]
  v_mfma_f32_16x16x32_bf16 v[116:119], v[76:79], v[180:183], v[116:119]
  v_mfma_f32_16x16x32_bf16 v[116:119], v[72:75], v[188:191], v[116:119]
  v_mfma_f32_16x16x32_bf16 v[112:115], v[72:75], v[184:187], v[112:115]
  v_mfma_f32_16x16x32_bf16 v[112:115], v[76:79], v[176:179], v[112:115]
  v_mfma_f32_16x16x32_bf16 v[112:115], v[48:51], v[168:171], v[112:115]
  ds_read_b128 v[84:87], v1 offset:33216
  v_mfma_f32_16x16x32_bf16 v[112:115], v[52:55], v[160:163], v[112:115]
  ds_read_b128 v[80:83], v1 offset:33232
  v_mfma_f32_16x16x32_bf16 v[112:115], v[68:71], v[192:195], v[112:115]
  ds_read_b128 v[56:59], v1 offset:33248
  v_mfma_f32_16x16x32_bf16 v[112:115], v[64:67], v[200:203], v[112:115]
  ds_read_b128 v[60:63], v1 offset:33264
  s_waitcnt lgkmcnt(5)
  v_mfma_f32_16x16x32_bf16 v[112:115], v[40:43], v[208:211], v[112:115]
  ds_read_b128 v[32:35], v2 offset:0
  s_waitcnt lgkmcnt(5)
  v_mfma_f32_16x16x32_bf16 v[112:115], v[44:47], v[216:219], v[112:115]
  ds_read_b128 v[36:39], v2 offset:16
  v_mfma_f32_16x16x32_bf16 v[116:119], v[44:47], v[220:223], v[116:119]
  ds_read_b128 v[72:75], v2 offset:32
  v_mfma_f32_16x16x32_bf16 v[116:119], v[40:43], v[212:215], v[116:119]
  ds_read_b128 v[76:79], v2 offset:48
  v_mfma_f32_16x16x32_bf16 v[116:119], v[64:67], v[204:207], v[116:119]
  ds_read_b128 v[48:51], v2 offset:64
  v_mfma_f32_16x16x32_bf16 v[116:119], v[68:71], v[196:199], v[116:119]
  ds_read_b128 v[52:55], v2 offset:80
  s_waitcnt lgkmcnt(8)
  v_mfma_f32_16x16x32_bf16 v[116:119], v[84:87], v[228:231], v[116:119]
  ds_read_b128 v[44:47], v2 offset:96
  v_mfma_f32_16x16x32_bf16 v[116:119], v[80:83], v[236:239], v[116:119]
  s_waitcnt lgkmcnt(7)
  v_mfma_f32_16x16x32_bf16 v[116:119], v[56:59], v[244:247], v[116:119]
  ds_read_b128 v[40:43], v2 offset:112
  v_mfma_f32_16x16x32_bf16 v[116:119], v[60:63], v[252:255], v[116:119]
  v_mfma_f32_16x16x32_bf16 v[112:115], v[60:63], v[248:251], v[112:115]
  ds_read_b128 v[64:67], v2 offset:128
  v_mfma_f32_16x16x32_bf16 v[112:115], v[56:59], v[240:243], v[112:115]
  v_mfma_f32_16x16x32_bf16 v[112:115], v[80:83], v[232:235], v[112:115]
  ds_read_b128 v[68:71], v2 offset:144
  v_mfma_f32_16x16x32_bf16 v[112:115], v[84:87], v[224:227], v[112:115]
  s_barrier
  ds_read_b128 v[18:21], v7 offset:8192
  ds_read_b128 v[22:25], v7 offset:12288
  ds_read_b128 v[60:63], v2 offset:160
  ds_read_b128 v[56:59], v2 offset:176
  s_waitcnt lgkmcnt(2)
  s_nop 1
  v_add_f32 v112, v112, v18
  v_add_f32 v116, v116, v22
  v_add_f32 v114, v114, v20
  v_add_f32 v118, v118, v24
  v_add_f32 v113, v113, v19
  v_add_f32 v117, v117, v23
  v_add_f32 v115, v115, v21
  v_add_f32_e64 v119, v119, v25
  v_cvt_pk_bf16_f32 v18, v112, v116
  v_cvt_pk_bf16_f32 v20, v114, v118
  v_cvt_pk_bf16_f32 v19, v113, v117
  v_cvt_pk_bf16_f32 v21, v115, v119
  v_mov_b32 v22, v18
  v_mov_b32 v23, v19
  v_mov_b32_dpp v18, v20 row_ror:8 row_mask:0xf bank_mask:0xc
  v_mov_b32_dpp v19, v21 row_ror:8 row_mask:0xf bank_mask:0xc
  v_mov_b32_dpp v20, v22 row_ror:8 row_mask:0xf bank_mask:0x3
  v_mov_b32_dpp v21, v23 row_ror:8 row_mask:0xf bank_mask:0x3
  v_mov_b32 v22, v18
  v_mov_b32 v23, v20
  v_mov_b32_dpp v18, v19 row_shr:4 row_mask:0xf bank_mask:0xa
  v_mov_b32_dpp v20, v21 row_shr:4 row_mask:0xf bank_mask:0xa
  v_mov_b32_dpp v19, v22 row_shl:4 row_mask:0xf bank_mask:0x5
  v_mov_b32_dpp v21, v23 row_shl:4 row_mask:0xf bank_mask:0x5
  s_add_u32 s39, s32, 1490944
  buffer_store_dwordx4 v[18:21], v8, s[24:27], s39 offen sc1
  v_mfma_f32_16x16x32_bf16 v[120:123], v[32:35], v[128:131], 0
  v_mfma_f32_16x16x32_bf16 v[120:123], v[36:39], v[136:139], v[120:123]
  v_mfma_f32_16x16x32_bf16 v[120:123], v[72:75], v[144:147], v[120:123]
  v_mfma_f32_16x16x32_bf16 v[120:123], v[76:79], v[152:155], v[120:123]
  v_mfma_f32_16x16x32_bf16 v[124:127], v[76:79], v[156:159], 0
  v_mfma_f32_16x16x32_bf16 v[124:127], v[72:75], v[148:151], v[124:127]
  v_mfma_f32_16x16x32_bf16 v[124:127], v[36:39], v[140:143], v[124:127]
  v_mfma_f32_16x16x32_bf16 v[124:127], v[32:35], v[132:135], v[124:127]
  v_mfma_f32_16x16x32_bf16 v[124:127], v[48:51], v[164:167], v[124:127]
  v_mfma_f32_16x16x32_bf16 v[124:127], v[52:55], v[172:175], v[124:127]
  v_mfma_f32_16x16x32_bf16 v[124:127], v[44:47], v[180:183], v[124:127]
  v_mfma_f32_16x16x32_bf16 v[124:127], v[40:43], v[188:191], v[124:127]
  v_mfma_f32_16x16x32_bf16 v[120:123], v[40:43], v[184:187], v[120:123]
  v_mfma_f32_16x16x32_bf16 v[120:123], v[44:47], v[176:179], v[120:123]
  v_mfma_f32_16x16x32_bf16 v[120:123], v[52:55], v[168:171], v[120:123]
  ds_read_b128 v[80:83], v2 offset:192
  v_mfma_f32_16x16x32_bf16 v[120:123], v[48:51], v[160:163], v[120:123]
  ds_read_b128 v[84:87], v2 offset:208
  s_barrier
  ds_read_b128 v[10:13], v7 offset:16384
  ds_read_b128 v[14:17], v7 offset:20480
  v_mfma_f32_16x16x32_bf16 v[120:123], v[64:67], v[192:195], v[120:123]
  ds_read_b128 v[76:79], v2 offset:224
  v_mfma_f32_16x16x32_bf16 v[120:123], v[68:71], v[200:203], v[120:123]
  ds_read_b128 v[72:75], v2 offset:240
  s_waitcnt lgkmcnt(7)
  v_mfma_f32_16x16x32_bf16 v[120:123], v[60:63], v[208:211], v[120:123]
  s_waitcnt lgkmcnt(6)
  v_mfma_f32_16x16x32_bf16 v[120:123], v[56:59], v[216:219], v[120:123]
  v_mfma_f32_16x16x32_bf16 v[124:127], v[56:59], v[220:223], v[124:127]
  v_mfma_f32_16x16x32_bf16 v[124:127], v[60:63], v[212:215], v[124:127]
  v_mfma_f32_16x16x32_bf16 v[124:127], v[68:71], v[204:207], v[124:127]
  v_mfma_f32_16x16x32_bf16 v[124:127], v[64:67], v[196:199], v[124:127]
  s_waitcnt lgkmcnt(5)
  v_mfma_f32_16x16x32_bf16 v[124:127], v[80:83], v[228:231], v[124:127]
  s_waitcnt lgkmcnt(4)
  v_mfma_f32_16x16x32_bf16 v[124:127], v[84:87], v[236:239], v[124:127]
  s_waitcnt lgkmcnt(1)
  v_mfma_f32_16x16x32_bf16 v[124:127], v[76:79], v[244:247], v[124:127]
  s_waitcnt lgkmcnt(0)
  v_mfma_f32_16x16x32_bf16 v[124:127], v[72:75], v[252:255], v[124:127]
  v_mfma_f32_16x16x32_bf16 v[120:123], v[72:75], v[248:251], v[120:123]
  v_mfma_f32_16x16x32_bf16 v[120:123], v[76:79], v[240:243], v[120:123]
  v_mfma_f32_16x16x32_bf16 v[120:123], v[84:87], v[232:235], v[120:123]
  v_mfma_f32_16x16x32_bf16 v[120:123], v[80:83], v[224:227], v[120:123]
  s_nop 7
  v_add_f32 v120, v120, v10
  v_add_f32 v124, v124, v14
  v_add_f32 v122, v122, v12
  v_add_f32 v126, v126, v16
  v_add_f32 v121, v121, v11
  v_add_f32 v125, v125, v15
  v_add_f32 v123, v123, v13
  v_add_f32 v127, v127, v17
  v_cvt_pk_bf16_f32 v10, v120, v124
  v_cvt_pk_bf16_f32 v12, v122, v126
  v_cvt_pk_bf16_f32 v11, v121, v125
  v_cvt_pk_bf16_f32 v13, v123, v127
  v_mov_b32 v14, v10
  v_mov_b32 v15, v11
  v_mov_b32_dpp v10, v12 row_ror:8 row_mask:0xf bank_mask:0xc
  v_mov_b32_dpp v11, v13 row_ror:8 row_mask:0xf bank_mask:0xc
  v_mov_b32_dpp v12, v14 row_ror:8 row_mask:0xf bank_mask:0x3
  v_mov_b32_dpp v13, v15 row_ror:8 row_mask:0xf bank_mask:0x3
  v_mov_b32 v14, v10
  v_mov_b32 v15, v12
  v_mov_b32_dpp v10, v11 row_shr:4 row_mask:0xf bank_mask:0xa
  v_mov_b32_dpp v12, v13 row_shr:4 row_mask:0xf bank_mask:0xa
  v_mov_b32_dpp v11, v14 row_shl:4 row_mask:0xf bank_mask:0x5
  v_mov_b32_dpp v13, v15 row_shl:4 row_mask:0xf bank_mask:0x5
  s_add_u32 s39, s32, 1605632
  buffer_store_dwordx4 v[10:13], v8, s[24:27], s39 offen sc1
  s_endpgm
.p2align 3
L_B:
  s_nop 1
  ds_read_b128 v[32:35], v1 offset:0
  ds_read_b128 v[36:39], v1 offset:16
  ds_read_b128 v[40:43], v1 offset:32
  ds_read_b128 v[44:47], v1 offset:48
  ds_read_b128 v[48:51], v1 offset:64
  ds_read_b128 v[52:55], v1 offset:80
  ds_read_b128 v[56:59], v1 offset:96
  ds_read_b128 v[60:63], v1 offset:112
  ds_read_b128 v[64:67], v1 offset:128
  ds_read_b128 v[68:71], v1 offset:144
  ds_read_b128 v[72:75], v1 offset:160
  ds_read_b128 v[76:79], v1 offset:176
  s_setprio 1
  s_waitcnt lgkmcnt(10)
  v_mfma_f32_16x16x32_bf16 v[88:91], v[32:35], v[128:131], 0
  ds_read_b128 v[80:83], v1 offset:192
  v_mfma_f32_16x16x32_bf16 v[88:91], v[36:39], v[136:139], v[88:91]
  s_waitcnt lgkmcnt(9)
  v_mfma_f32_16x16x32_bf16 v[88:91], v[40:43], v[144:147], v[88:91]
  ds_read_b128 v[84:87], v1 offset:208
  v_mfma_f32_16x16x32_bf16 v[88:91], v[44:47], v[152:155], v[88:91]
  v_mfma_f32_16x16x32_bf16 v[92:95], v[44:47], v[156:159], 0
  ds_read_b128 v[18:21], v1 offset:224
  v_mfma_f32_16x16x32_bf16 v[92:95], v[40:43], v[148:151], v[92:95]
  v_mfma_f32_16x16x32_bf16 v[92:95], v[36:39], v[140:143], v[92:95]
  ds_read_b128 v[22:25], v1 offset:240
  v_mfma_f32_16x16x32_bf16 v[92:95], v[32:35], v[132:135], v[92:95]
  s_waitcnt lgkmcnt(10)
  v_mfma_f32_16x16x32_bf16 v[92:95], v[48:51], v[164:167], v[92:95]
  ds_read_b128 v[26:29], v1 offset:33024
  v_mfma_f32_16x16x32_bf16 v[92:95], v[52:55], v[172:175], v[92:95]
  s_waitcnt lgkmcnt(9)
  v_mfma_f32_16x16x32_bf16 v[92:95], v[56:59], v[180:183], v[92:95]
  ds_read_b128 v[44:47], v1 offset:33040
  v_mfma_f32_16x16x32_bf16 v[92:95], v[60:63], v[188:191], v[92:95]
  v_mfma_f32_16x16x32_bf16 v[88:91], v[60:63], v[184:187], v[88:91]
  ds_read_b128 v[40:43], v1 offset:33056
  v_mfma_f32_16x16x32_bf16 v[88:91], v[56:59], v[176:179], v[88:91]
  v_mfma_f32_16x16x32_bf16 v[88:91], v[52:55], v[168:171], v[88:91]
  ds_read_b128 v[36:39], v1 offset:33072
  v_mfma_f32_16x16x32_bf16 v[88:91], v[48:51], v[160:163], v[88:91]
  s_waitcnt lgkmcnt(10)
  v_mfma_f32_16x16x32_bf16 v[88:91], v[64:67], v[192:195], v[88:91]
  ds_read_b128 v[32:35], v1 offset:33088
  v_mfma_f32_16x16x32_bf16 v[88:91], v[68:71], v[200:203], v[88:91]
  s_waitcnt lgkmcnt(9)
  v_mfma_f32_16x16x32_bf16 v[88:91], v[72:75], v[208:211], v[88:91]
  ds_read_b128 v[60:63], v1 offset:33104
  v_mfma_f32_16x16x32_bf16 v[88:91], v[76:79], v[216:219], v[88:91]
  v_mfma_f32_16x16x32_bf16 v[92:95], v[76:79], v[220:223], v[92:95]
  ds_read_b128 v[56:59], v1 offset:33120
  v_mfma_f32_16x16x32_bf16 v[92:95], v[72:75], v[212:215], v[92:95]
  v_mfma_f32_16x16x32_bf16 v[92:95], v[68:71], v[204:207], v[92:95]
  ds_read_b128 v[52:55], v1 offset:33136
  v_mfma_f32_16x16x32_bf16 v[92:95], v[64:67], v[196:199], v[92:95]
  s_waitcnt lgkmcnt(10)
  v_mfma_f32_16x16x32_bf16 v[92:95], v[80:83], v[228:231], v[92:95]
  ds_read_b128 v[48:51], v1 offset:33152
  v_mfma_f32_16x16x32_bf16 v[92:95], v[84:87], v[236:239], v[92:95]
  s_waitcnt lgkmcnt(9)
  v_mfma_f32_16x16x32_bf16 v[92:95], v[18:21], v[244:247], v[92:95]
  ds_read_b128 v[76:79], v1 offset:33168
  v_mfma_f32_16x16x32_bf16 v[92:95], v[22:25], v[252:255], v[92:95]
  v_mfma_f32_16x16x32_bf16 v[88:91], v[22:25], v[248:251], v[88:91]
  ds_read_b128 v[72:75], v1 offset:33184
  v_mfma_f32_16x16x32_bf16 v[88:91], v[18:21], v[240:243], v[88:91]
  v_mfma_f32_16x16x32_bf16 v[88:91], v[84:87], v[232:235], v[88:91]
  ds_read_b128 v[68:71], v1 offset:33200
  v_mfma_f32_16x16x32_bf16 v[88:91], v[80:83], v[224:227], v[88:91]
  s_barrier
  s_waitcnt lgkmcnt(10)
  v_mfma_f32_16x16x32_bf16 v[96:99], v[26:29], v[128:131], 0
  v_mfma_f32_16x16x32_bf16 v[96:99], v[44:47], v[136:139], v[96:99]
  s_waitcnt lgkmcnt(8)
  v_mfma_f32_16x16x32_bf16 v[96:99], v[40:43], v[144:147], v[96:99]
  v_mfma_f32_16x16x32_bf16 v[96:99], v[36:39], v[152:155], v[96:99]
  v_mfma_f32_16x16x32_bf16 v[100:103], v[36:39], v[156:159], 0
  ds_write_b128 v7, v[88:91] offset:0
  ds_write_b128 v7, v[92:95] offset:4096
  v_mfma_f32_16x16x32_bf16 v[100:103], v[40:43], v[148:151], v[100:103]
  v_mfma_f32_16x16x32_bf16 v[100:103], v[44:47], v[140:143], v[100:103]
  v_mfma_f32_16x16x32_bf16 v[100:103], v[26:29], v[132:135], v[100:103]
  s_waitcnt lgkmcnt(8)
  v_mfma_f32_16x16x32_bf16 v[100:103], v[32:35], v[164:167], v[100:103]
  v_mfma_f32_16x16x32_bf16 v[100:103], v[60:63], v[172:175], v[100:103]
  s_waitcnt lgkmcnt(7)
  v_mfma_f32_16x16x32_bf16 v[100:103], v[56:59], v[180:183], v[100:103]
  s_waitcnt lgkmcnt(6)
  v_mfma_f32_16x16x32_bf16 v[100:103], v[52:55], v[188:191], v[100:103]
  v_mfma_f32_16x16x32_bf16 v[96:99], v[52:55], v[184:187], v[96:99]
  v_mfma_f32_16x16x32_bf16 v[96:99], v[56:59], v[176:179], v[96:99]
  v_mfma_f32_16x16x32_bf16 v[96:99], v[60:63], v[168:171], v[96:99]
  v_mfma_f32_16x16x32_bf16 v[96:99], v[32:35], v[160:163], v[96:99]
  s_waitcnt lgkmcnt(5)
  v_mfma_f32_16x16x32_bf16 v[96:99], v[48:51], v[192:195], v[96:99]
  ds_read_b128 v[64:67], v1 offset:33216
  s_waitcnt lgkmcnt(5)
  v_mfma_f32_16x16x32_bf16 v[96:99], v[76:79], v[200:203], v[96:99]
  ds_read_b128 v[22:25], v1 offset:33232
  s_waitcnt lgkmcnt(5)
  v_mfma_f32_16x16x32_bf16 v[96:99], v[72:75], v[208:211], v[96:99]
  ds_read_b128 v[18:21], v1 offset:33248
  s_waitcnt lgkmcnt(5)
  v_mfma_f32_16x16x32_bf16 v[96:99], v[68:71], v[216:219], v[96:99]
  ds_read_b128 v[84:87], v1 offset:33264
  v_mfma_f32_16x16x32_bf16 v[100:103], v[68:71], v[220:223], v[100:103]
  ds_read_b128 v[80:83], v2 offset:0
  v_mfma_f32_16x16x32_bf16 v[100:103], v[72:75], v[212:215], v[100:103]
  ds_read_b128 v[36:39], v2 offset:16
  v_mfma_f32_16x16x32_bf16 v[100:103], v[76:79], v[204:207], v[100:103]
  ds_read_b128 v[40:43], v2 offset:32
  v_mfma_f32_16x16x32_bf16 v[100:103], v[48:51], v[196:199], v[100:103]
  ds_read_b128 v[44:47], v2 offset:48
  s_waitcnt lgkmcnt(6)
  v_mfma_f32_16x16x32_bf16 v[100:103], v[64:67], v[228:231], v[100:103]
  ds_read_b128 v[26:29], v2 offset:64
  v_mfma_f32_16x16x32_bf16 v[100:103], v[22:25], v[236:239], v[100:103]
  ds_read_b128 v[52:55], v2 offset:80
  s_waitcnt lgkmcnt(6)
  v_mfma_f32_16x16x32_bf16 v[100:103], v[18:21], v[244:247], v[100:103]
  ds_read_b128 v[56:59], v2 offset:96
  v_mfma_f32_16x16x32_bf16 v[100:103], v[84:87], v[252:255], v[100:103]
  ds_read_b128 v[60:63], v2 offset:112
  v_mfma_f32_16x16x32_bf16 v[96:99], v[84:87], v[248:251], v[96:99]
  ds_read_b128 v[32:35], v2 offset:128
  v_mfma_f32_16x16x32_bf16 v[96:99], v[18:21], v[240:243], v[96:99]
  v_mfma_f32_16x16x32_bf16 v[96:99], v[22:25], v[232:235], v[96:99]
  ds_read_b128 v[68:71], v2 offset:144
  v_mfma_f32_16x16x32_bf16 v[96:99], v[64:67], v[224:227], v[96:99]
  s_barrier
  s_waitcnt lgkmcnt(8)
  v_mfma_f32_16x16x32_bf16 v[104:107], v[80:83], v[128:131], 0
  v_mfma_f32_16x16x32_bf16 v[104:107], v[36:39], v[136:139], v[104:107]
  s_waitcnt lgkmcnt(6)
  v_mfma_f32_16x16x32_bf16 v[104:107], v[40:43], v[144:147], v[104:107]
  v_mfma_f32_16x16x32_bf16 v[104:107], v[44:47], v[152:155], v[104:107]
  v_mfma_f32_16x16x32_bf16 v[108:111], v[44:47], v[156:159], 0
  ds_write_b128 v7, v[96:99] offset:8192
  ds_write_b128 v7, v[100:103] offset:12288
  v_mfma_f32_16x16x32_bf16 v[108:111], v[40:43], v[148:151], v[108:111]
  v_mfma_f32_16x16x32_bf16 v[108:111], v[36:39], v[140:143], v[108:111]
  v_mfma_f32_16x16x32_bf16 v[108:111], v[80:83], v[132:135], v[108:111]
  s_waitcnt lgkmcnt(7)
  v_mfma_f32_16x16x32_bf16 v[108:111], v[26:29], v[164:167], v[108:111]
  ds_read_b128 v[72:75], v2 offset:160
  s_waitcnt lgkmcnt(7)
  v_mfma_f32_16x16x32_bf16 v[108:111], v[52:55], v[172:175], v[108:111]
  s_waitcnt lgkmcnt(6)
  v_mfma_f32_16x16x32_bf16 v[108:111], v[56:59], v[180:183], v[108:111]
  s_waitcnt lgkmcnt(5)
  v_mfma_f32_16x16x32_bf16 v[108:111], v[60:63], v[188:191], v[108:111]
  v_mfma_f32_16x16x32_bf16 v[104:107], v[60:63], v[184:187], v[104:107]
  v_mfma_f32_16x16x32_bf16 v[104:107], v[56:59], v[176:179], v[104:107]
  v_mfma_f32_16x16x32_bf16 v[104:107], v[52:55], v[168:171], v[104:107]
  v_mfma_f32_16x16x32_bf16 v[104:107], v[26:29], v[160:163], v[104:107]
  s_waitcnt lgkmcnt(4)
  v_mfma_f32_16x16x32_bf16 v[104:107], v[32:35], v[192:195], v[104:107]
  ds_read_b128 v[76:79], v2 offset:176
  s_waitcnt lgkmcnt(4)
  v_mfma_f32_16x16x32_bf16 v[104:107], v[68:71], v[200:203], v[104:107]
  ds_read_b128 v[48:51], v2 offset:192
  s_waitcnt lgkmcnt(2)
  v_mfma_f32_16x16x32_bf16 v[104:107], v[72:75], v[208:211], v[104:107]
  ds_read_b128 v[84:87], v2 offset:208
  s_waitcnt lgkmcnt(2)
  v_mfma_f32_16x16x32_bf16 v[104:107], v[76:79], v[216:219], v[104:107]
  ds_read_b128 v[18:21], v2 offset:224
  v_mfma_f32_16x16x32_bf16 v[108:111], v[76:79], v[220:223], v[108:111]
  ds_read_b128 v[22:25], v2 offset:240
  v_mfma_f32_16x16x32_bf16 v[108:111], v[72:75], v[212:215], v[108:111]
  ds_read_b128 v[64:67], v2 offset:33024
  v_mfma_f32_16x16x32_bf16 v[108:111], v[68:71], v[204:207], v[108:111]
  ds_read_b128 v[44:47], v2 offset:33040
  v_mfma_f32_16x16x32_bf16 v[108:111], v[32:35], v[196:199], v[108:111]
  ds_read_b128 v[40:43], v2 offset:33056
  s_waitcnt lgkmcnt(5)
  v_mfma_f32_16x16x32_bf16 v[108:111], v[48:51], v[228:231], v[108:111]
  ds_read_b128 v[36:39], v2 offset:33072
  v_mfma_f32_16x16x32_bf16 v[108:111], v[84:87], v[236:239], v[108:111]
  ds_read_b128 v[80:83], v2 offset:33088
  s_waitcnt lgkmcnt(5)
  v_mfma_f32_16x16x32_bf16 v[108:111], v[18:21], v[244:247], v[108:111]
  ds_read_b128 v[60:63], v2 offset:33104
  v_mfma_f32_16x16x32_bf16 v[108:111], v[22:25], v[252:255], v[108:111]
  ds_read_b128 v[56:59], v2 offset:33120
  v_mfma_f32_16x16x32_bf16 v[104:107], v[22:25], v[248:251], v[104:107]
  ds_read_b128 v[52:55], v2 offset:33136
  v_mfma_f32_16x16x32_bf16 v[104:107], v[18:21], v[240:243], v[104:107]
  ds_read_b128 v[26:29], v2 offset:33152
  v_mfma_f32_16x16x32_bf16 v[104:107], v[84:87], v[232:235], v[104:107]
  ds_read_b128 v[76:79], v2 offset:33168
  v_mfma_f32_16x16x32_bf16 v[104:107], v[48:51], v[224:227], v[104:107]
  s_barrier
  s_waitcnt lgkmcnt(8)
  v_mfma_f32_16x16x32_bf16 v[112:115], v[64:67], v[128:131], 0
  v_mfma_f32_16x16x32_bf16 v[112:115], v[44:47], v[136:139], v[112:115]
  s_waitcnt lgkmcnt(6)
  v_mfma_f32_16x16x32_bf16 v[112:115], v[40:43], v[144:147], v[112:115]
  v_mfma_f32_16x16x32_bf16 v[112:115], v[36:39], v[152:155], v[112:115]
  v_mfma_f32_16x16x32_bf16 v[116:119], v[36:39], v[156:159], 0
  ds_write_b128 v7, v[104:107] offset:16384
  ds_write_b128 v7, v[108:111] offset:20480
  v_mfma_f32_16x16x32_bf16 v[116:119], v[40:43], v[148:151], v[116:119]
  v_mfma_f32_16x16x32_bf16 v[116:119], v[44:47], v[140:143], v[116:119]
  v_mfma_f32_16x16x32_bf16 v[116:119], v[64:67], v[132:135], v[116:119]
  s_waitcnt lgkmcnt(7)
  v_mfma_f32_16x16x32_bf16 v[116:119], v[80:83], v[164:167], v[116:119]
  ds_read_b128 v[72:75], v2 offset:33184
  s_waitcnt lgkmcnt(7)
  v_mfma_f32_16x16x32_bf16 v[116:119], v[60:63], v[172:175], v[116:119]
  s_waitcnt lgkmcnt(6)
  v_mfma_f32_16x16x32_bf16 v[116:119], v[56:59], v[180:183], v[116:119]
  s_waitcnt lgkmcnt(5)
  v_mfma_f32_16x16x32_bf16 v[116:119], v[52:55], v[188:191], v[116:119]
  v_mfma_f32_16x16x32_bf16 v[112:115], v[52:55], v[184:187], v[112:115]
  v_mfma_f32_16x16x32_bf16 v[112:115], v[56:59], v[176:179], v[112:115]
  v_mfma_f32_16x16x32_bf16 v[112:115], v[60:63], v[168:171], v[112:115]
  v_mfma_f32_16x16x32_bf16 v[112:115], v[80:83], v[160:163], v[112:115]
  s_waitcnt lgkmcnt(4)
  v_mfma_f32_16x16x32_bf16 v[112:115], v[26:29], v[192:195], v[112:115]
  ds_read_b128 v[68:71], v2 offset:33200
  s_waitcnt lgkmcnt(4)
  v_mfma_f32_16x16x32_bf16 v[112:115], v[76:79], v[200:203], v[112:115]
  ds_read_b128 v[32:35], v2 offset:33216
  s_waitcnt lgkmcnt(2)
  v_mfma_f32_16x16x32_bf16 v[112:115], v[72:75], v[208:211], v[112:115]
  ds_read_b128 v[22:25], v2 offset:33232
  s_waitcnt lgkmcnt(2)
  v_mfma_f32_16x16x32_bf16 v[112:115], v[68:71], v[216:219], v[112:115]
  ds_read_b128 v[18:21], v2 offset:33248
  v_mfma_f32_16x16x32_bf16 v[116:119], v[68:71], v[220:223], v[116:119]
  ds_read_b128 v[84:87], v2 offset:33264
  v_mfma_f32_16x16x32_bf16 v[116:119], v[72:75], v[212:215], v[116:119]
  ds_read_b128 v[48:51], v1 offset:0
  v_mfma_f32_16x16x32_bf16 v[116:119], v[76:79], v[204:207], v[116:119]
  ds_read_b128 v[36:39], v1 offset:16
  v_mfma_f32_16x16x32_bf16 v[116:119], v[26:29], v[196:199], v[116:119]
  ds_read_b128 v[40:43], v1 offset:32
  s_waitcnt lgkmcnt(5)
  v_mfma_f32_16x16x32_bf16 v[116:119], v[32:35], v[228:231], v[116:119]
  ds_read_b128 v[44:47], v1 offset:48
  v_mfma_f32_16x16x32_bf16 v[116:119], v[22:25], v[236:239], v[116:119]
  ds_read_b128 v[64:67], v1 offset:64
  s_waitcnt lgkmcnt(5)
  v_mfma_f32_16x16x32_bf16 v[116:119], v[18:21], v[244:247], v[116:119]
  ds_read_b128 v[52:55], v1 offset:80
  v_mfma_f32_16x16x32_bf16 v[116:119], v[84:87], v[252:255], v[116:119]
  ds_read_b128 v[56:59], v1 offset:96
  v_mfma_f32_16x16x32_bf16 v[112:115], v[84:87], v[248:251], v[112:115]
  ds_read_b128 v[60:63], v1 offset:112
  v_mfma_f32_16x16x32_bf16 v[112:115], v[18:21], v[240:243], v[112:115]
  ds_read_b128 v[80:83], v1 offset:128
  v_mfma_f32_16x16x32_bf16 v[112:115], v[22:25], v[232:235], v[112:115]
  ds_read_b128 v[68:71], v1 offset:144
  v_mfma_f32_16x16x32_bf16 v[112:115], v[32:35], v[224:227], v[112:115]
  s_barrier
  s_waitcnt lgkmcnt(8)
  v_mfma_f32_16x16x32_bf16 v[120:123], v[48:51], v[128:131], 0
  v_mfma_f32_16x16x32_bf16 v[120:123], v[36:39], v[136:139], v[120:123]
  s_waitcnt lgkmcnt(6)
  v_mfma_f32_16x16x32_bf16 v[120:123], v[40:43], v[144:147], v[120:123]
  v_mfma_f32_16x16x32_bf16 v[120:123], v[44:47], v[152:155], v[120:123]
  v_mfma_f32_16x16x32_bf16 v[124:127], v[44:47], v[156:159], 0
  ds_write_b128 v7, v[112:115] offset:0
  ds_write_b128 v7, v[116:119] offset:4096
  v_mfma_f32_16x16x32_bf16 v[124:127], v[40:43], v[148:151], v[124:127]
  v_mfma_f32_16x16x32_bf16 v[124:127], v[36:39], v[140:143], v[124:127]
  v_mfma_f32_16x16x32_bf16 v[124:127], v[48:51], v[132:135], v[124:127]
  s_waitcnt lgkmcnt(7)
  v_mfma_f32_16x16x32_bf16 v[124:127], v[64:67], v[164:167], v[124:127]
  ds_read_b128 v[72:75], v1 offset:160
  s_waitcnt lgkmcnt(7)
  v_mfma_f32_16x16x32_bf16 v[124:127], v[52:55], v[172:175], v[124:127]
  s_waitcnt lgkmcnt(6)
  v_mfma_f32_16x16x32_bf16 v[124:127], v[56:59], v[180:183], v[124:127]
  s_waitcnt lgkmcnt(5)
  v_mfma_f32_16x16x32_bf16 v[124:127], v[60:63], v[188:191], v[124:127]
  v_mfma_f32_16x16x32_bf16 v[120:123], v[60:63], v[184:187], v[120:123]
  v_mfma_f32_16x16x32_bf16 v[120:123], v[56:59], v[176:179], v[120:123]
  v_mfma_f32_16x16x32_bf16 v[120:123], v[52:55], v[168:171], v[120:123]
  v_mfma_f32_16x16x32_bf16 v[120:123], v[64:67], v[160:163], v[120:123]
  s_waitcnt lgkmcnt(4)
  v_mfma_f32_16x16x32_bf16 v[120:123], v[80:83], v[192:195], v[120:123]
  ds_read_b128 v[76:79], v1 offset:176
  s_waitcnt lgkmcnt(4)
  v_mfma_f32_16x16x32_bf16 v[120:123], v[68:71], v[200:203], v[120:123]
  ds_read_b128 v[26:29], v1 offset:192
  s_waitcnt lgkmcnt(2)
  v_mfma_f32_16x16x32_bf16 v[120:123], v[72:75], v[208:211], v[120:123]
  ds_read_b128 v[84:87], v1 offset:208
  s_waitcnt lgkmcnt(2)
  v_mfma_f32_16x16x32_bf16 v[120:123], v[76:79], v[216:219], v[120:123]
  ds_read_b128 v[18:21], v1 offset:224
  v_mfma_f32_16x16x32_bf16 v[124:127], v[76:79], v[220:223], v[124:127]
  ds_read_b128 v[22:25], v1 offset:240
  v_mfma_f32_16x16x32_bf16 v[124:127], v[72:75], v[212:215], v[124:127]
  ds_read_b128 v[32:35], v1 offset:33024
  v_mfma_f32_16x16x32_bf16 v[124:127], v[68:71], v[204:207], v[124:127]
  ds_read_b128 v[44:47], v1 offset:33040
  v_mfma_f32_16x16x32_bf16 v[124:127], v[80:83], v[196:199], v[124:127]
  ds_read_b128 v[40:43], v1 offset:33056
  s_waitcnt lgkmcnt(5)
  v_mfma_f32_16x16x32_bf16 v[124:127], v[26:29], v[228:231], v[124:127]
  ds_read_b128 v[36:39], v1 offset:33072
  v_mfma_f32_16x16x32_bf16 v[124:127], v[84:87], v[236:239], v[124:127]
  ds_read_b128 v[48:51], v1 offset:33088
  s_waitcnt lgkmcnt(5)
  v_mfma_f32_16x16x32_bf16 v[124:127], v[18:21], v[244:247], v[124:127]
  ds_read_b128 v[60:63], v1 offset:33104
  v_mfma_f32_16x16x32_bf16 v[124:127], v[22:25], v[252:255], v[124:127]
  ds_read_b128 v[56:59], v1 offset:33120
  v_mfma_f32_16x16x32_bf16 v[120:123], v[22:25], v[248:251], v[120:123]
  ds_read_b128 v[52:55], v1 offset:33136
  v_mfma_f32_16x16x32_bf16 v[120:123], v[18:21], v[240:243], v[120:123]
  ds_read_b128 v[64:67], v1 offset:33152
  v_mfma_f32_16x16x32_bf16 v[120:123], v[84:87], v[232:235], v[120:123]
  ds_read_b128 v[76:79], v1 offset:33168
  v_mfma_f32_16x16x32_bf16 v[120:123], v[26:29], v[224:227], v[120:123]
  s_nop 7
  ds_write_b128 v7, v[120:123] offset:8192
  ds_write_b128 v7, v[124:127] offset:12288
  s_add_u32 m0, s29, 101136
  s_add_u32 s40, s28, 230520
  buffer_load_dwordx4 v3, s[8:11], s40 offen  lds
  ds_read_b128 v[72:75], v1 offset:33184
  ds_read_b128 v[68:71], v1 offset:33200
  buffer_load_dwordx4 v4, s[96:99], s40 offen offset:1024  lds
  s_add_u32 m0, s29, 103200
  s_add_u32 s40, s28, 232560
  buffer_load_dwordx4 v3, s[8:11], s40 offen  lds
  buffer_load_dwordx4 v4, s[96:99], s40 offen offset:1024  lds
  s_add_u32 m0, s29, 105264
  s_add_u32 s40, s28, 234600
  buffer_load_dwordx4 v3, s[8:11], s40 offen  lds
  buffer_load_dwordx4 v4, s[96:99], s40 offen offset:1024  lds
  s_waitcnt lgkmcnt(2)
  s_barrier
  v_mfma_f32_16x16x32_bf16 v[88:91], v[32:35], v[128:131], 0
  ds_read_b128 v[80:83], v1 offset:33216
  v_mfma_f32_16x16x32_bf16 v[88:91], v[44:47], v[136:139], v[88:91]
  v_mfma_f32_16x16x32_bf16 v[88:91], v[40:43], v[144:147], v[88:91]
  ds_read_b128 v[22:25], v1 offset:33232
  v_mfma_f32_16x16x32_bf16 v[88:91], v[36:39], v[152:155], v[88:91]
  v_mfma_f32_16x16x32_bf16 v[92:95], v[36:39], v[156:159], 0
  ds_read_b128 v[18:21], v1 offset:33248
  v_mfma_f32_16x16x32_bf16 v[92:95], v[40:43], v[148:151], v[92:95]
  v_mfma_f32_16x16x32_bf16 v[92:95], v[44:47], v[140:143], v[92:95]
  ds_read_b128 v[84:87], v1 offset:33264
  v_mfma_f32_16x16x32_bf16 v[92:95], v[32:35], v[132:135], v[92:95]
  v_mfma_f32_16x16x32_bf16 v[92:95], v[48:51], v[164:167], v[92:95]
  ds_read_b128 v[26:29], v2 offset:0
  v_mfma_f32_16x16x32_bf16 v[92:95], v[60:63], v[172:175], v[92:95]
  v_mfma_f32_16x16x32_bf16 v[92:95], v[56:59], v[180:183], v[92:95]
  ds_read_b128 v[36:39], v2 offset:16
  v_mfma_f32_16x16x32_bf16 v[92:95], v[52:55], v[188:191], v[92:95]
  v_mfma_f32_16x16x32_bf16 v[88:91], v[52:55], v[184:187], v[88:91]
  ds_read_b128 v[40:43], v2 offset:32
  v_mfma_f32_16x16x32_bf16 v[88:91], v[56:59], v[176:179], v[88:91]
  v_mfma_f32_16x16x32_bf16 v[88:91], v[60:63], v[168:171], v[88:91]
  ds_read_b128 v[44:47], v2 offset:48
  v_mfma_f32_16x16x32_bf16 v[88:91], v[48:51], v[160:163], v[88:91]
  v_mfma_f32_16x16x32_bf16 v[88:91], v[64:67], v[192:195], v[88:91]
  ds_read_b128 v[32:35], v2 offset:64
  v_mfma_f32_16x16x32_bf16 v[88:91], v[76:79], v[200:203], v[88:91]
  s_waitcnt lgkmcnt(9)
  v_mfma_f32_16x16x32_bf16 v[88:91], v[72:75], v[208:211], v[88:91]
  ds_read_b128 v[52:55], v2 offset:80
  v_mfma_f32_16x16x32_bf16 v[88:91], v[68:71], v[216:219], v[88:91]
  v_mfma_f32_16x16x32_bf16 v[92:95], v[68:71], v[220:223], v[92:95]
  ds_read_b128 v[56:59], v2 offset:96
  v_mfma_f32_16x16x32_bf16 v[92:95], v[72:75], v[212:215], v[92:95]
  v_mfma_f32_16x16x32_bf16 v[92:95], v[76:79], v[204:207], v[92:95]
  ds_read_b128 v[60:63], v2 offset:112
  v_mfma_f32_16x16x32_bf16 v[92:95], v[64:67], v[196:199], v[92:95]
  s_waitcnt lgkmcnt(10)
  v_mfma_f32_16x16x32_bf16 v[92:95], v[80:83], v[228:231], v[92:95]
  ds_read_b128 v[48:51], v2 offset:128
  v_mfma_f32_16x16x32_bf16 v[92:95], v[22:25], v[236:239], v[92:95]
  s_waitcnt lgkmcnt(9)
  v_mfma_f32_16x16x32_bf16 v[92:95], v[18:21], v[244:247], v[92:95]
  ds_read_b128 v[68:71], v2 offset:144
  v_mfma_f32_16x16x32_bf16 v[92:95], v[84:87], v[252:255], v[92:95]
  v_mfma_f32_16x16x32_bf16 v[88:91], v[84:87], v[248:251], v[88:91]
  ds_read_b128 v[72:75], v2 offset:160
  v_mfma_f32_16x16x32_bf16 v[88:91], v[18:21], v[240:243], v[88:91]
  v_mfma_f32_16x16x32_bf16 v[88:91], v[22:25], v[232:235], v[88:91]
  ds_read_b128 v[76:79], v2 offset:176
  v_mfma_f32_16x16x32_bf16 v[88:91], v[80:83], v[224:227], v[88:91]
  s_nop 7
  ds_write_b128 v7, v[88:91] offset:16384
  ds_write_b128 v7, v[92:95] offset:20480
  s_add_u32 m0, s29, 0
  s_add_u32 s40, s28, 261120
  buffer_load_dwordx4 v4, s[96:99], s40 offen offset:1024  lds
  s_add_u32 m0, s29, 2064
  s_add_u32 s40, s28, 263160
  buffer_load_dwordx4 v3, s[8:11], s40 offen  lds
  buffer_load_dwordx4 v4, s[96:99], s40 offen offset:1024  lds
  s_add_u32 m0, s29, 4128
  s_add_u32 s40, s28, 265200
  buffer_load_dwordx4 v3, s[8:11], s40 offen  lds
  buffer_load_dwordx4 v4, s[96:99], s40 offen offset:1024  lds
  s_add_u32 m0, s29, 6192
  s_add_u32 s40, s28, 267240
  buffer_load_dwordx4 v3, s[8:11], s40 offen  lds
  buffer_load_dwordx4 v4, s[96:99], s40 offen offset:1024  lds
  s_waitcnt vmcnt(7) lgkmcnt(0)
  s_barrier
  v_mfma_f32_16x16x32_bf16 v[96:99], v[26:29], v[128:131], 0
  ds_read_b128 v[64:67], v2 offset:192
  v_mfma_f32_16x16x32_bf16 v[96:99], v[36:39], v[136:139], v[96:99]
  v_mfma_f32_16x16x32_bf16 v[96:99], v[40:43], v[144:147], v[96:99]
  ds_read_b128 v[84:87], v2 offset:208
  v_mfma_f32_16x16x32_bf16 v[96:99], v[44:47], v[152:155], v[96:99]
  v_mfma_f32_16x16x32_bf16 v[100:103], v[44:47], v[156:159], 0
  ds_read_b128 v[18:21], v2 offset:224
  v_mfma_f32_16x16x32_bf16 v[100:103], v[40:43], v[148:151], v[100:103]
  v_mfma_f32_16x16x32_bf16 v[100:103], v[36:39], v[140:143], v[100:103]
  ds_read_b128 v[22:25], v2 offset:240
  v_mfma_f32_16x16x32_bf16 v[100:103], v[26:29], v[132:135], v[100:103]
  v_mfma_f32_16x16x32_bf16 v[100:103], v[32:35], v[164:167], v[100:103]
  ds_read_b128 v[80:83], v2 offset:33024
  v_mfma_f32_16x16x32_bf16 v[100:103], v[52:55], v[172:175], v[100:103]
  v_mfma_f32_16x16x32_bf16 v[100:103], v[56:59], v[180:183], v[100:103]
  ds_read_b128 v[44:47], v2 offset:33040
  v_mfma_f32_16x16x32_bf16 v[100:103], v[60:63], v[188:191], v[100:103]
  v_mfma_f32_16x16x32_bf16 v[96:99], v[60:63], v[184:187], v[96:99]
  ds_read_b128 v[40:43], v2 offset:33056
  v_mfma_f32_16x16x32_bf16 v[96:99], v[56:59], v[176:179], v[96:99]
  v_mfma_f32_16x16x32_bf16 v[96:99], v[52:55], v[168:171], v[96:99]
  ds_read_b128 v[36:39], v2 offset:33072
  v_mfma_f32_16x16x32_bf16 v[96:99], v[32:35], v[160:163], v[96:99]
  v_mfma_f32_16x16x32_bf16 v[96:99], v[48:51], v[192:195], v[96:99]
  ds_read_b128 v[26:29], v2 offset:33088
  v_mfma_f32_16x16x32_bf16 v[96:99], v[68:71], v[200:203], v[96:99]
  v_mfma_f32_16x16x32_bf16 v[96:99], v[72:75], v[208:211], v[96:99]
  ds_read_b128 v[60:63], v2 offset:33104
  v_mfma_f32_16x16x32_bf16 v[96:99], v[76:79], v[216:219], v[96:99]
  v_mfma_f32_16x16x32_bf16 v[100:103], v[76:79], v[220:223], v[100:103]
  ds_read_b128 v[56:59], v2 offset:33120
  v_mfma_f32_16x16x32_bf16 v[100:103], v[72:75], v[212:215], v[100:103]
  v_mfma_f32_16x16x32_bf16 v[100:103], v[68:71], v[204:207], v[100:103]
  ds_read_b128 v[52:55], v2 offset:33136
  v_mfma_f32_16x16x32_bf16 v[100:103], v[48:51], v[196:199], v[100:103]
  s_waitcnt lgkmcnt(10)
  v_mfma_f32_16x16x32_bf16 v[100:103], v[64:67], v[228:231], v[100:103]
  ds_read_b128 v[32:35], v2 offset:33152
  v_mfma_f32_16x16x32_bf16 v[100:103], v[84:87], v[236:239], v[100:103]
  s_waitcnt lgkmcnt(9)
  v_mfma_f32_16x16x32_bf16 v[100:103], v[18:21], v[244:247], v[100:103]
  ds_read_b128 v[76:79], v2 offset:33168
  v_mfma_f32_16x16x32_bf16 v[100:103], v[22:25], v[252:255], v[100:103]
  v_mfma_f32_16x16x32_bf16 v[96:99], v[22:25], v[248:251], v[96:99]
  ds_read_b128 v[72:75], v2 offset:33184
  v_mfma_f32_16x16x32_bf16 v[96:99], v[18:21], v[240:243], v[96:99]
  v_mfma_f32_16x16x32_bf16 v[96:99], v[84:87], v[232:235], v[96:99]
  ds_read_b128 v[68:71], v2 offset:33200
  v_mfma_f32_16x16x32_bf16 v[96:99], v[64:67], v[224:227], v[96:99]
  s_nop 7
  ds_write_b128 v7, v[96:99] offset:0
  ds_write_b128 v7, v[100:103] offset:4096
  s_add_u32 m0, s29, 35088
  s_add_u32 s40, s28, 295800
  buffer_load_dwordx4 v3, s[8:11], s40 offen  lds
  buffer_load_dwordx4 v4, s[96:99], s40 offen offset:1024  lds
  s_add_u32 m0, s29, 37152
  s_add_u32 s40, s28, 297840
  buffer_load_dwordx4 v3, s[8:11], s40 offen  lds
  buffer_load_dwordx4 v4, s[96:99], s40 offen offset:1024  lds
  s_add_u32 m0, s29, 39216
  s_add_u32 s40, s28, 299880
  buffer_load_dwordx4 v3, s[8:11], s40 offen  lds
  buffer_load_dwordx4 v4, s[96:99], s40 offen offset:1024  lds
  s_waitcnt vmcnt(6) lgkmcnt(0)
  s_barrier
  v_mfma_f32_16x16x32_bf16 v[104:107], v[80:83], v[128:131], 0
  ds_read_b128 v[48:51], v2 offset:33216
  v_mfma_f32_16x16x32_bf16 v[104:107], v[44:47], v[136:139], v[104:107]
  v_mfma_f32_16x16x32_bf16 v[104:107], v[40:43], v[144:147], v[104:107]
  ds_read_b128 v[22:25], v2 offset:33232
  v_mfma_f32_16x16x32_bf16 v[104:107], v[36:39], v[152:155], v[104:107]
  v_mfma_f32_16x16x32_bf16 v[108:111], v[36:39], v[156:159], 0
  ds_read_b128 v[18:21], v2 offset:33248
  v_mfma_f32_16x16x32_bf16 v[108:111], v[40:43], v[148:151], v[108:111]
  v_mfma_f32_16x16x32_bf16 v[108:111], v[44:47], v[140:143], v[108:111]
  ds_read_b128 v[84:87], v2 offset:33264
  v_mfma_f32_16x16x32_bf16 v[108:111], v[80:83], v[132:135], v[108:111]
  v_mfma_f32_16x16x32_bf16 v[108:111], v[26:29], v[164:167], v[108:111]
  ds_read_b128 v[64:67], v1 offset:0
  v_mfma_f32_16x16x32_bf16 v[108:111], v[60:63], v[172:175], v[108:111]
  v_mfma_f32_16x16x32_bf16 v[108:111], v[56:59], v[180:183], v[108:111]
  ds_read_b128 v[36:39], v1 offset:16
  v_mfma_f32_16x16x32_bf16 v[108:111], v[52:55], v[188:191], v[108:111]
  v_mfma_f32_16x16x32_bf16 v[104:107], v[52:55], v[184:187], v[104:107]
  ds_read_b128 v[40:43], v1 offset:32
  v_mfma_f32_16x16x32_bf16 v[104:107], v[56:59], v[176:179], v[104:107]
  v_mfma_f32_16x16x32_bf16 v[104:107], v[60:63], v[168:171], v[104:107]
  ds_read_b128 v[44:47], v1 offset:48
  v_mfma_f32_16x16x32_bf16 v[104:107], v[26:29], v[160:163], v[104:107]
  v_mfma_f32_16x16x32_bf16 v[104:107], v[32:35], v[192:195], v[104:107]
  ds_read_b128 v[80:83], v1 offset:64
  v_mfma_f32_16x16x32_bf16 v[104:107], v[76:79], v[200:203], v[104:107]
  v_mfma_f32_16x16x32_bf16 v[104:107], v[72:75], v[208:211], v[104:107]
  ds_read_b128 v[52:55], v1 offset:80
  v_mfma_f32_16x16x32_bf16 v[104:107], v[68:71], v[216:219], v[104:107]
  v_mfma_f32_16x16x32_bf16 v[108:111], v[68:71], v[220:223], v[108:111]
  ds_read_b128 v[56:59], v1 offset:96
  v_mfma_f32_16x16x32_bf16 v[108:111], v[72:75], v[212:215], v[108:111]
  v_mfma_f32_16x16x32_bf16 v[108:111], v[76:79], v[204:207], v[108:111]
  ds_read_b128 v[60:63], v1 offset:112
  v_mfma_f32_16x16x32_bf16 v[108:111], v[32:35], v[196:199], v[108:111]
  s_waitcnt lgkmcnt(10)
  v_mfma_f32_16x16x32_bf16 v[108:111], v[48:51], v[228:231], v[108:111]
  ds_read_b128 v[26:29], v1 offset:128
  v_mfma_f32_16x16x32_bf16 v[108:111], v[22:25], v[236:239], v[108:111]
  s_waitcnt lgkmcnt(9)
  v_mfma_f32_16x16x32_bf16 v[108:111], v[18:21], v[244:247], v[108:111]
  ds_read_b128 v[68:71], v1 offset:144
  v_mfma_f32_16x16x32_bf16 v[108:111], v[84:87], v[252:255], v[108:111]
  v_mfma_f32_16x16x32_bf16 v[104:107], v[84:87], v[248:251], v[104:107]
  ds_read_b128 v[72:75], v1 offset:160
  v_mfma_f32_16x16x32_bf16 v[104:107], v[18:21], v[240:243], v[104:107]
  v_mfma_f32_16x16x32_bf16 v[104:107], v[22:25], v[232:235], v[104:107]
  ds_read_b128 v[76:79], v1 offset:176
  v_mfma_f32_16x16x32_bf16 v[104:107], v[48:51], v[224:227], v[104:107]
  s_nop 7
  ds_write_b128 v7, v[104:107] offset:8192
  ds_write_b128 v7, v[108:111] offset:12288
  s_add_u32 m0, s29, 68112
  s_add_u32 s40, s28, 328440
  buffer_load_dwordx4 v3, s[8:11], s40 offen  lds
  buffer_load_dwordx4 v4, s[96:99], s40 offen offset:1024  lds
  s_add_u32 m0, s29, 70176
  s_add_u32 s40, s28, 330480
  buffer_load_dwordx4 v3, s[8:11], s40 offen  lds
  buffer_load_dwordx4 v4, s[96:99], s40 offen offset:1024  lds
  s_add_u32 m0, s29, 72240
  s_add_u32 s40, s28, 332520
  buffer_load_dwordx4 v3, s[8:11], s40 offen  lds
  buffer_load_dwordx4 v4, s[96:99], s40 offen offset:1024  lds
  s_waitcnt vmcnt(6) lgkmcnt(0)
  s_barrier
  v_mfma_f32_16x16x32_bf16 v[112:115], v[64:67], v[128:131], 0
  ds_read_b128 v[32:35], v1 offset:192
  v_mfma_f32_16x16x32_bf16 v[112:115], v[36:39], v[136:139], v[112:115]
  v_mfma_f32_16x16x32_bf16 v[112:115], v[40:43], v[144:147], v[112:115]
  ds_read_b128 v[84:87], v1 offset:208
  v_mfma_f32_16x16x32_bf16 v[112:115], v[44:47], v[152:155], v[112:115]
  v_mfma_f32_16x16x32_bf16 v[116:119], v[44:47], v[156:159], 0
  ds_read_b128 v[18:21], v1 offset:224
  v_mfma_f32_16x16x32_bf16 v[116:119], v[40:43], v[148:151], v[116:119]
  v_mfma_f32_16x16x32_bf16 v[116:119], v[36:39], v[140:143], v[116:119]
  ds_read_b128 v[22:25], v1 offset:240
  v_mfma_f32_16x16x32_bf16 v[116:119], v[64:67], v[132:135], v[116:119]
  v_mfma_f32_16x16x32_bf16 v[116:119], v[80:83], v[164:167], v[116:119]
  ds_read_b128 v[48:51], v1 offset:33024
  v_mfma_f32_16x16x32_bf16 v[116:119], v[52:55], v[172:175], v[116:119]
  v_mfma_f32_16x16x32_bf16 v[116:119], v[56:59], v[180:183], v[116:119]
  ds_read_b128 v[44:47], v1 offset:33040
  v_mfma_f32_16x16x32_bf16 v[116:119], v[60:63], v[188:191], v[116:119]
  v_mfma_f32_16x16x32_bf16 v[112:115], v[60:63], v[184:187], v[112:115]
  ds_read_b128 v[40:43], v1 offset:33056
  v_mfma_f32_16x16x32_bf16 v[112:115], v[56:59], v[176:179], v[112:115]
  v_mfma_f32_16x16x32_bf16 v[112:115], v[52:55], v[168:171], v[112:115]
  ds_read_b128 v[36:39], v1 offset:33072
  v_mfma_f32_16x16x32_bf16 v[112:115], v[80:83], v[160:163], v[112:115]
  v_mfma_f32_16x16x32_bf16 v[112:115], v[26:29], v[192:195], v[112:115]
  ds_read_b128 v[64:67], v1 offset:33088
  v_mfma_f32_16x16x32_bf16 v[112:115], v[68:71], v[200:203], v[112:115]
  v_mfma_f32_16x16x32_bf16 v[112:115], v[72:75], v[208:211], v[112:115]
  ds_read_b128 v[60:63], v1 offset:33104
  v_mfma_f32_16x16x32_bf16 v[112:115], v[76:79], v[216:219], v[112:115]
  v_mfma_f32_16x16x32_bf16 v[116:119], v[76:79], v[220:223], v[116:119]
  ds_read_b128 v[56:59], v1 offset:33120
  v_mfma_f32_16x16x32_bf16 v[116:119], v[72:75], v[212:215], v[116:119]
  v_mfma_f32_16x16x32_bf16 v[116:119], v[68:71], v[204:207], v[116:119]
  ds_read_b128 v[52:55], v1 offset:33136
  v_mfma_f32_16x16x32_bf16 v[116:119], v[26:29], v[196:199], v[116:119]
  s_waitcnt lgkmcnt(10)
  v_mfma_f32_16x16x32_bf16 v[116:119], v[32:35], v[228:231], v[116:119]
  ds_read_b128 v[80:83], v1 offset:33152
  v_mfma_f32_16x16x32_bf16 v[116:119], v[84:87], v[236:239], v[116:119]
  s_waitcnt lgkmcnt(9)
  v_mfma_f32_16x16x32_bf16 v[116:119], v[18:21], v[244:247], v[116:119]
  ds_read_b128 v[76:79], v1 offset:33168
  v_mfma_f32_16x16x32_bf16 v[116:119], v[22:25], v[252:255], v[116:119]
  v_mfma_f32_16x16x32_bf16 v[112:115], v[22:25], v[248:251], v[112:115]
  ds_read_b128 v[72:75], v1 offset:33184
  v_mfma_f32_16x16x32_bf16 v[112:115], v[18:21], v[240:243], v[112:115]
  v_mfma_f32_16x16x32_bf16 v[112:115], v[84:87], v[232:235], v[112:115]
  ds_read_b128 v[68:71], v1 offset:33200
  v_mfma_f32_16x16x32_bf16 v[112:115], v[32:35], v[224:227], v[112:115]
  s_nop 7
  ds_write_b128 v7, v[112:115] offset:16384
  ds_write_b128 v7, v[116:119] offset:20480
  s_add_u32 m0, s29, 101136
  s_add_u32 s40, s28, 361080
  buffer_load_dwordx4 v3, s[8:11], s40 offen  lds
  buffer_load_dwordx4 v4, s[96:99], s40 offen offset:1024  lds
  s_add_u32 m0, s29, 103200
  s_add_u32 s40, s28, 363120
  buffer_load_dwordx4 v3, s[8:11], s40 offen  lds
  buffer_load_dwordx4 v4, s[96:99], s40 offen offset:1024  lds
  s_add_u32 m0, s29, 105264
  s_add_u32 s40, s28, 365160
  buffer_load_dwordx4 v3, s[8:11], s40 offen  lds
  buffer_load_dwordx4 v4, s[96:99], s40 offen offset:1024  lds
  s_waitcnt vmcnt(6) lgkmcnt(0)
  s_barrier
  v_mfma_f32_16x16x32_bf16 v[120:123], v[48:51], v[128:131], 0
  ds_read_b128 v[26:29], v1 offset:33216
  v_mfma_f32_16x16x32_bf16 v[120:123], v[44:47], v[136:139], v[120:123]
  v_mfma_f32_16x16x32_bf16 v[120:123], v[40:43], v[144:147], v[120:123]
  ds_read_b128 v[22:25], v1 offset:33232
  v_mfma_f32_16x16x32_bf16 v[120:123], v[36:39], v[152:155], v[120:123]
  v_mfma_f32_16x16x32_bf16 v[124:127], v[36:39], v[156:159], 0
  ds_read_b128 v[18:21], v1 offset:33248
  v_mfma_f32_16x16x32_bf16 v[124:127], v[40:43], v[148:151], v[124:127]
  v_mfma_f32_16x16x32_bf16 v[124:127], v[44:47], v[140:143], v[124:127]
  ds_read_b128 v[84:87], v1 offset:33264
  v_mfma_f32_16x16x32_bf16 v[124:127], v[48:51], v[132:135], v[124:127]
  v_mfma_f32_16x16x32_bf16 v[124:127], v[64:67], v[164:167], v[124:127]
  ds_read_b128 v[32:35], v2 offset:0
  v_mfma_f32_16x16x32_bf16 v[124:127], v[60:63], v[172:175], v[124:127]
  v_mfma_f32_16x16x32_bf16 v[124:127], v[56:59], v[180:183], v[124:127]
  ds_read_b128 v[36:39], v2 offset:16
  v_mfma_f32_16x16x32_bf16 v[124:127], v[52:55], v[188:191], v[124:127]
  v_mfma_f32_16x16x32_bf16 v[120:123], v[52:55], v[184:187], v[120:123]
  ds_read_b128 v[40:43], v2 offset:32
  v_mfma_f32_16x16x32_bf16 v[120:123], v[56:59], v[176:179], v[120:123]
  v_mfma_f32_16x16x32_bf16 v[120:123], v[60:63], v[168:171], v[120:123]
  ds_read_b128 v[44:47], v2 offset:48
  v_mfma_f32_16x16x32_bf16 v[120:123], v[64:67], v[160:163], v[120:123]
  v_mfma_f32_16x16x32_bf16 v[120:123], v[80:83], v[192:195], v[120:123]
  ds_read_b128 v[48:51], v2 offset:64
  v_mfma_f32_16x16x32_bf16 v[120:123], v[76:79], v[200:203], v[120:123]
  v_mfma_f32_16x16x32_bf16 v[120:123], v[72:75], v[208:211], v[120:123]
  ds_read_b128 v[52:55], v2 offset:80
  v_mfma_f32_16x16x32_bf16 v[120:123], v[68:71], v[216:219], v[120:123]
  v_mfma_f32_16x16x32_bf16 v[124:127], v[68:71], v[220:223], v[124:127]
  ds_read_b128 v[56:59], v2 offset:96
  v_mfma_f32_16x16x32_bf16 v[124:127], v[72:75], v[212:215], v[124:127]
  v_mfma_f32_16x16x32_bf16 v[124:127], v[76:79], v[204:207], v[124:127]
  ds_read_b128 v[60:63], v2 offset:112
  v_mfma_f32_16x16x32_bf16 v[124:127], v[80:83], v[196:199], v[124:127]
  s_waitcnt lgkmcnt(10)
  v_mfma_f32_16x16x32_bf16 v[124:127], v[26:29], v[228:231], v[124:127]
  ds_read_b128 v[64:67], v2 offset:128
  v_mfma_f32_16x16x32_bf16 v[124:127], v[22:25], v[236:239], v[124:127]
  s_waitcnt lgkmcnt(9)
  v_mfma_f32_16x16x32_bf16 v[124:127], v[18:21], v[244:247], v[124:127]
  ds_read_b128 v[68:71], v2 offset:144
  v_mfma_f32_16x16x32_bf16 v[124:127], v[84:87], v[252:255], v[124:127]
  v_mfma_f32_16x16x32_bf16 v[120:123], v[84:87], v[248:251], v[120:123]
  ds_read_b128 v[72:75], v2 offset:160
  v_mfma_f32_16x16x32_bf16 v[120:123], v[18:21], v[240:243], v[120:123]
  v_mfma_f32_16x16x32_bf16 v[120:123], v[22:25], v[232:235], v[120:123]
  ds_read_b128 v[76:79], v2 offset:176
  v_mfma_f32_16x16x32_bf16 v[120:123], v[26:29], v[224:227], v[120:123]
  s_nop 7
  ds_write_b128 v7, v[120:123] offset:0
  ds_write_b128 v7, v[124:127] offset:4096
  s_add_u32 m0, s29, 2064
  s_add_u32 s40, s28, 393720
  buffer_load_dwordx4 v3, s[8:11], s40 offen  lds
  buffer_load_dwordx4 v4, s[96:99], s40 offen offset:1024  lds
  s_add_u32 m0, s29, 4128
  s_add_u32 s40, s28, 395760
  buffer_load_dwordx4 v3, s[8:11], s40 offen  lds
  buffer_load_dwordx4 v4, s[96:99], s40 offen offset:1024  lds
  s_add_u32 m0, s29, 6192
  s_add_u32 s40, s28, 397800
  buffer_load_dwordx4 v3, s[8:11], s40 offen  lds
  buffer_load_dwordx4 v4, s[96:99], s40 offen offset:1024  lds
  s_waitcnt vmcnt(6) lgkmcnt(0)
  s_barrier
  v_mfma_f32_16x16x32_bf16 v[88:91], v[32:35], v[128:131], 0
  ds_read_b128 v[80:83], v2 offset:192
  v_mfma_f32_16x16x32_bf16 v[88:91], v[36:39], v[136:139], v[88:91]
  v_mfma_f32_16x16x32_bf16 v[88:91], v[40:43], v[144:147], v[88:91]
  ds_read_b128 v[84:87], v2 offset:208
  v_mfma_f32_16x16x32_bf16 v[88:91], v[44:47], v[152:155], v[88:91]
  v_mfma_f32_16x16x32_bf16 v[92:95], v[44:47], v[156:159], 0
  ds_read_b128 v[18:21], v2 offset:224
  v_mfma_f32_16x16x32_bf16 v[92:95], v[40:43], v[148:151], v[92:95]
  v_mfma_f32_16x16x32_bf16 v[92:95], v[36:39], v[140:143], v[92:95]
  ds_read_b128 v[22:25], v2 offset:240
  v_mfma_f32_16x16x32_bf16 v[92:95], v[32:35], v[132:135], v[92:95]
  v_mfma_f32_16x16x32_bf16 v[92:95], v[48:51], v[164:167], v[92:95]
  ds_read_b128 v[26:29], v2 offset:33024
  v_mfma_f32_16x16x32_bf16 v[92:95], v[52:55], v[172:175], v[92:95]
  v_mfma_f32_16x16x32_bf16 v[92:95], v[56:59], v[180:183], v[92:95]
  ds_read_b128 v[44:47], v2 offset:33040
  v_mfma_f32_16x16x32_bf16 v[92:95], v[60:63], v[188:191], v[92:95]
  v_mfma_f32_16x16x32_bf16 v[88:91], v[60:63], v[184:187], v[88:91]
  ds_read_b128 v[40:43], v2 offset:33056
  v_mfma_f32_16x16x32_bf16 v[88:91], v[56:59], v[176:179], v[88:91]
  v_mfma_f32_16x16x32_bf16 v[88:91], v[52:55], v[168:171], v[88:91]
  ds_read_b128 v[36:39], v2 offset:33072
  v_mfma_f32_16x16x32_bf16 v[88:91], v[48:51], v[160:163], v[88:91]
  v_mfma_f32_16x16x32_bf16 v[88:91], v[64:67], v[192:195], v[88:91]
  ds_read_b128 v[32:35], v2 offset:33088
  v_mfma_f32_16x16x32_bf16 v[88:91], v[68:71], v[200:203], v[88:91]
  v_mfma_f32_16x16x32_bf16 v[88:91], v[72:75], v[208:211], v[88:91]
  ds_read_b128 v[60:63], v2 offset:33104
  v_mfma_f32_16x16x32_bf16 v[88:91], v[76:79], v[216:219], v[88:91]
  v_mfma_f32_16x16x32_bf16 v[92:95], v[76:79], v[220:223], v[92:95]
  ds_read_b128 v[56:59], v2 offset:33120
  v_mfma_f32_16x16x32_bf16 v[92:95], v[72:75], v[212:215], v[92:95]
  v_mfma_f32_16x16x32_bf16 v[92:95], v[68:71], v[204:207], v[92:95]
  ds_read_b128 v[52:55], v2 offset:33136
  v_mfma_f32_16x16x32_bf16 v[92:95], v[64:67], v[196:199], v[92:95]
  s_waitcnt lgkmcnt(10)
  v_mfma_f32_16x16x32_bf16 v[92:95], v[80:83], v[228:231], v[92:95]
  ds_read_b128 v[48:51], v2 offset:33152
  v_mfma_f32_16x16x32_bf16 v[92:95], v[84:87], v[236:239], v[92:95]
  s_waitcnt lgkmcnt(9)
  v_mfma_f32_16x16x32_bf16 v[92:95], v[18:21], v[244:247], v[92:95]
  ds_read_b128 v[76:79], v2 offset:33168
  v_mfma_f32_16x16x32_bf16 v[92:95], v[22:25], v[252:255], v[92:95]
  v_mfma_f32_16x16x32_bf16 v[88:91], v[22:25], v[248:251], v[88:91]
  ds_read_b128 v[72:75], v2 offset:33184
  v_mfma_f32_16x16x32_bf16 v[88:91], v[18:21], v[240:243], v[88:91]
  v_mfma_f32_16x16x32_bf16 v[88:91], v[84:87], v[232:235], v[88:91]
  ds_read_b128 v[68:71], v2 offset:33200
  v_mfma_f32_16x16x32_bf16 v[88:91], v[80:83], v[224:227], v[88:91]
  s_nop 7
  ds_write_b128 v7, v[88:91] offset:8192
  ds_write_b128 v7, v[92:95] offset:12288
  s_add_u32 m0, s29, 35088
  s_add_u32 s40, s28, 426360
  buffer_load_dwordx4 v3, s[8:11], s40 offen  lds
  buffer_load_dwordx4 v4, s[96:99], s40 offen offset:1024  lds
  s_add_u32 m0, s29, 37152
  s_add_u32 s40, s28, 428400
  buffer_load_dwordx4 v3, s[8:11], s40 offen  lds
  buffer_load_dwordx4 v4, s[96:99], s40 offen offset:1024  lds
  s_add_u32 m0, s29, 39216
  s_add_u32 s40, s28, 430440
  buffer_load_dwordx4 v3, s[8:11], s40 offen  lds
  buffer_load_dwordx4 v4, s[96:99], s40 offen offset:1024  lds
  s_waitcnt vmcnt(6) lgkmcnt(0)
  s_barrier
  s_cmp_eq_u32 s34, 1
  s_cbranch_scc1 L_t15_1
  v_mfma_f32_16x16x32_bf16 v[96:99], v[26:29], v[128:131], 0
  ds_read_b128 v[64:67], v2 offset:33216
  v_mfma_f32_16x16x32_bf16 v[96:99], v[44:47], v[136:139], v[96:99]
  v_mfma_f32_16x16x32_bf16 v[96:99], v[40:43], v[144:147], v[96:99]
  ds_read_b128 v[22:25], v2 offset:33232
  v_mfma_f32_16x16x32_bf16 v[96:99], v[36:39], v[152:155], v[96:99]
  v_mfma_f32_16x16x32_bf16 v[100:103], v[36:39], v[156:159], 0
  ds_read_b128 v[18:21], v2 offset:33248
  v_mfma_f32_16x16x32_bf16 v[100:103], v[40:43], v[148:151], v[100:103]
  v_mfma_f32_16x16x32_bf16 v[100:103], v[44:47], v[140:143], v[100:103]
  ds_read_b128 v[84:87], v2 offset:33264
  v_mfma_f32_16x16x32_bf16 v[100:103], v[26:29], v[132:135], v[100:103]
  v_mfma_f32_16x16x32_bf16 v[100:103], v[32:35], v[164:167], v[100:103]
  ds_read_b128 v[80:83], v1 offset:0
  v_mfma_f32_16x16x32_bf16 v[100:103], v[60:63], v[172:175], v[100:103]
  v_mfma_f32_16x16x32_bf16 v[100:103], v[56:59], v[180:183], v[100:103]
  ds_read_b128 v[36:39], v1 offset:16
  v_mfma_f32_16x16x32_bf16 v[100:103], v[52:55], v[188:191], v[100:103]
  v_mfma_f32_16x16x32_bf16 v[96:99], v[52:55], v[184:187], v[96:99]
  ds_read_b128 v[40:43], v1 offset:32
  v_mfma_f32_16x16x32_bf16 v[96:99], v[56:59], v[176:179], v[96:99]
  v_mfma_f32_16x16x32_bf16 v[96:99], v[60:63], v[168:171], v[96:99]
  ds_read_b128 v[44:47], v1 offset:48
  v_mfma_f32_16x16x32_bf16 v[96:99], v[32:35], v[160:163], v[96:99]
  v_mfma_f32_16x16x32_bf16 v[96:99], v[48:51], v[192:195], v[96:99]
  ds_read_b128 v[26:29], v1 offset:64
  v_mfma_f32_16x16x32_bf16 v[96:99], v[76:79], v[200:203], v[96:99]
  v_mfma_f32_16x16x32_bf16 v[96:99], v[72:75], v[208:211], v[96:99]
  ds_read_b128 v[52:55], v1 offset:80
  v_mfma_f32_16x16x32_bf16 v[96:99], v[68:71], v[216:219], v[96:99]
  v_mfma_f32_16x16x32_bf16 v[100:103], v[68:71], v[220:223], v[100:103]
  ds_read_b128 v[56:59], v1 offset:96
  v_mfma_f32_16x16x32_bf16 v[100:103], v[72:75], v[212:215], v[100:103]
  v_mfma_f32_16x16x32_bf16 v[100:103], v[76:79], v[204:207], v[100:103]
  ds_read_b128 v[60:63], v1 offset:112
  v_mfma_f32_16x16x32_bf16 v[100:103], v[48:51], v[196:199], v[100:103]
  s_waitcnt lgkmcnt(10)
  v_mfma_f32_16x16x32_bf16 v[100:103], v[64:67], v[228:231], v[100:103]
  ds_read_b128 v[32:35], v1 offset:128
  v_mfma_f32_16x16x32_bf16 v[100:103], v[22:25], v[236:239], v[100:103]
  s_waitcnt lgkmcnt(9)
  v_mfma_f32_16x16x32_bf16 v[100:103], v[18:21], v[244:247], v[100:103]
  ds_read_b128 v[68:71], v1 offset:144
  v_mfma_f32_16x16x32_bf16 v[100:103], v[84:87], v[252:255], v[100:103]
  v_mfma_f32_16x16x32_bf16 v[96:99], v[84:87], v[248:251], v[96:99]
  ds_read_b128 v[72:75], v1 offset:160
  v_mfma_f32_16x16x32_bf16 v[96:99], v[18:21], v[240:243], v[96:99]
  v_mfma_f32_16x16x32_bf16 v[96:99], v[22:25], v[232:235], v[96:99]
  ds_read_b128 v[76:79], v1 offset:176
  v_mfma_f32_16x16x32_bf16 v[96:99], v[64:67], v[224:227], v[96:99]
  s_nop 7
  ds_write_b128 v7, v[96:99] offset:16384
  ds_write_b128 v7, v[100:103] offset:20480
  s_waitcnt vmcnt(0) lgkmcnt(0)
  s_barrier
  v_mfma_f32_16x16x32_bf16 v[104:107], v[80:83], v[128:131], 0
  ds_read_b128 v[48:51], v1 offset:192
  v_mfma_f32_16x16x32_bf16 v[104:107], v[36:39], v[136:139], v[104:107]
  v_mfma_f32_16x16x32_bf16 v[104:107], v[40:43], v[144:147], v[104:107]
  ds_read_b128 v[84:87], v1 offset:208
  v_mfma_f32_16x16x32_bf16 v[104:107], v[44:47], v[152:155], v[104:107]
  v_mfma_f32_16x16x32_bf16 v[108:111], v[44:47], v[156:159], 0
  ds_read_b128 v[18:21], v1 offset:224
  v_mfma_f32_16x16x32_bf16 v[108:111], v[40:43], v[148:151], v[108:111]
  v_mfma_f32_16x16x32_bf16 v[108:111], v[36:39], v[140:143], v[108:111]
  ds_read_b128 v[22:25], v1 offset:240
  v_mfma_f32_16x16x32_bf16 v[108:111], v[80:83], v[132:135], v[108:111]
  v_mfma_f32_16x16x32_bf16 v[108:111], v[26:29], v[164:167], v[108:111]
  ds_read_b128 v[64:67], v1 offset:33024
  v_mfma_f32_16x16x32_bf16 v[108:111], v[52:55], v[172:175], v[108:111]
  v_mfma_f32_16x16x32_bf16 v[108:111], v[56:59], v[180:183], v[108:111]
  ds_read_b128 v[44:47], v1 offset:33040
  v_mfma_f32_16x16x32_bf16 v[108:111], v[60:63], v[188:191], v[108:111]
  v_mfma_f32_16x16x32_bf16 v[104:107], v[60:63], v[184:187], v[104:107]
  ds_read_b128 v[40:43], v1 offset:33056
  v_mfma_f32_16x16x32_bf16 v[104:107], v[56:59], v[176:179], v[104:107]
  v_mfma_f32_16x16x32_bf16 v[104:107], v[52:55], v[168:171], v[104:107]
  ds_read_b128 v[36:39], v1 offset:33072
  v_mfma_f32_16x16x32_bf16 v[104:107], v[26:29], v[160:163], v[104:107]
  v_mfma_f32_16x16x32_bf16 v[104:107], v[32:35], v[192:195], v[104:107]
  ds_read_b128 v[80:83], v1 offset:33088
  v_mfma_f32_16x16x32_bf16 v[104:107], v[68:71], v[200:203], v[104:107]
  v_mfma_f32_16x16x32_bf16 v[104:107], v[72:75], v[208:211], v[104:107]
  ds_read_b128 v[60:63], v1 offset:33104
  v_mfma_f32_16x16x32_bf16 v[104:107], v[76:79], v[216:219], v[104:107]
  v_mfma_f32_16x16x32_bf16 v[108:111], v[76:79], v[220:223], v[108:111]
  ds_read_b128 v[56:59], v1 offset:33120
  v_mfma_f32_16x16x32_bf16 v[108:111], v[72:75], v[212:215], v[108:111]
  v_mfma_f32_16x16x32_bf16 v[108:111], v[68:71], v[204:207], v[108:111]
  ds_read_b128 v[52:55], v1 offset:33136
  v_mfma_f32_16x16x32_bf16 v[108:111], v[32:35], v[196:199], v[108:111]
  s_waitcnt lgkmcnt(10)
  v_mfma_f32_16x16x32_bf16 v[108:111], v[48:51], v[228:231], v[108:111]
  ds_read_b128 v[26:29], v1 offset:33152
  v_mfma_f32_16x16x32_bf16 v[108:111], v[84:87], v[236:239], v[108:111]
  s_waitcnt lgkmcnt(9)
  v_mfma_f32_16x16x32_bf16 v[108:111], v[18:21], v[244:247], v[108:111]
  ds_read_b128 v[76:79], v1 offset:33168
  v_mfma_f32_16x16x32_bf16 v[108:111], v[22:25], v[252:255], v[108:111]
  v_mfma_f32_16x16x32_bf16 v[104:107], v[22:25], v[248:251], v[104:107]
  ds_read_b128 v[72:75], v1 offset:33184
  v_mfma_f32_16x16x32_bf16 v[104:107], v[18:21], v[240:243], v[104:107]
  v_mfma_f32_16x16x32_bf16 v[104:107], v[84:87], v[232:235], v[104:107]
  ds_read_b128 v[68:71], v1 offset:33200
  v_mfma_f32_16x16x32_bf16 v[104:107], v[48:51], v[224:227], v[104:107]
  s_nop 7
  ds_write_b128 v7, v[104:107] offset:0
  ds_write_b128 v7, v[108:111] offset:4096
  s_waitcnt lgkmcnt(0)
  s_barrier
  v_mfma_f32_16x16x32_bf16 v[112:115], v[64:67], v[128:131], 0
  ds_read_b128 v[32:35], v1 offset:33216
  v_mfma_f32_16x16x32_bf16 v[112:115], v[44:47], v[136:139], v[112:115]
  v_mfma_f32_16x16x32_bf16 v[112:115], v[40:43], v[144:147], v[112:115]
  ds_read_b128 v[22:25], v1 offset:33232
  v_mfma_f32_16x16x32_bf16 v[112:115], v[36:39], v[152:155], v[112:115]
  v_mfma_f32_16x16x32_bf16 v[116:119], v[36:39], v[156:159], 0
  ds_read_b128 v[18:21], v1 offset:33248
  v_mfma_f32_16x16x32_bf16 v[116:119], v[40:43], v[148:151], v[116:119]
  v_mfma_f32_16x16x32_bf16 v[116:119], v[44:47], v[140:143], v[116:119]
  ds_read_b128 v[84:87], v1 offset:33264
  v_mfma_f32_16x16x32_bf16 v[116:119], v[64:67], v[132:135], v[116:119]
  v_mfma_f32_16x16x32_bf16 v[116:119], v[80:83], v[164:167], v[116:119]
  v_mfma_f32_16x16x32_bf16 v[116:119], v[60:63], v[172:175], v[116:119]
  v_mfma_f32_16x16x32_bf16 v[116:119], v[56:59], v[180:183], v[116:119]
  v_mfma_f32_16x16x32_bf16 v[116:119], v[52:55], v[188:191], v[116:119]
  v_mfma_f32_16x16x32_bf16 v[112:115], v[52:55], v[184:187], v[112:115]
  v_mfma_f32_16x16x32_bf16 v[112:115], v[56:59], v[176:179], v[112:115]
  v_mfma_f32_16x16x32_bf16 v[112:115], v[60:63], v[168:171], v[112:115]
  v_mfma_f32_16x16x32_bf16 v[112:115], v[80:83], v[160:163], v[112:115]
  v_mfma_f32_16x16x32_bf16 v[112:115], v[26:29], v[192:195], v[112:115]
  v_mfma_f32_16x16x32_bf16 v[112:115], v[76:79], v[200:203], v[112:115]
  v_mfma_f32_16x16x32_bf16 v[112:115], v[72:75], v[208:211], v[112:115]
  v_mfma_f32_16x16x32_bf16 v[112:115], v[68:71], v[216:219], v[112:115]
  v_mfma_f32_16x16x32_bf16 v[116:119], v[68:71], v[220:223], v[116:119]
  v_mfma_f32_16x16x32_bf16 v[116:119], v[72:75], v[212:215], v[116:119]
  v_mfma_f32_16x16x32_bf16 v[116:119], v[76:79], v[204:207], v[116:119]
  v_mfma_f32_16x16x32_bf16 v[116:119], v[26:29], v[196:199], v[116:119]
  s_waitcnt lgkmcnt(3)
  v_mfma_f32_16x16x32_bf16 v[116:119], v[32:35], v[228:231], v[116:119]
  s_waitcnt lgkmcnt(2)
  v_mfma_f32_16x16x32_bf16 v[116:119], v[22:25], v[236:239], v[116:119]
  s_waitcnt lgkmcnt(1)
  v_mfma_f32_16x16x32_bf16 v[116:119], v[18:21], v[244:247], v[116:119]
  s_waitcnt lgkmcnt(0)
  v_mfma_f32_16x16x32_bf16 v[116:119], v[84:87], v[252:255], v[116:119]
  v_mfma_f32_16x16x32_bf16 v[112:115], v[84:87], v[248:251], v[112:115]
  v_mfma_f32_16x16x32_bf16 v[112:115], v[18:21], v[240:243], v[112:115]
  v_mfma_f32_16x16x32_bf16 v[112:115], v[22:25], v[232:235], v[112:115]
  v_mfma_f32_16x16x32_bf16 v[112:115], v[32:35], v[224:227], v[112:115]
  s_nop 7
  ds_write_b128 v7, v[112:115] offset:8192
  ds_write_b128 v7, v[116:119] offset:12288
  s_waitcnt lgkmcnt(0)
  s_barrier
  s_endpgm
.p2align 3
L_t15_1:
  v_mfma_f32_16x16x32_bf16 v[96:99], v[26:29], v[128:131], 0
  ds_read_b128 v[64:67], v2 offset:33216
  v_mfma_f32_16x16x32_bf16 v[96:99], v[44:47], v[136:139], v[96:99]
  v_mfma_f32_16x16x32_bf16 v[96:99], v[40:43], v[144:147], v[96:99]
  ds_read_b128 v[22:25], v2 offset:33232
  v_mfma_f32_16x16x32_bf16 v[96:99], v[36:39], v[152:155], v[96:99]
  v_mfma_f32_16x16x32_bf16 v[100:103], v[36:39], v[156:159], 0
  ds_read_b128 v[18:21], v2 offset:33248
  v_mfma_f32_16x16x32_bf16 v[100:103], v[40:43], v[148:151], v[100:103]
  v_mfma_f32_16x16x32_bf16 v[100:103], v[44:47], v[140:143], v[100:103]
  ds_read_b128 v[84:87], v2 offset:33264
  v_mfma_f32_16x16x32_bf16 v[100:103], v[26:29], v[132:135], v[100:103]
  v_mfma_f32_16x16x32_bf16 v[100:103], v[32:35], v[164:167], v[100:103]
  ds_read_b128 v[80:83], v1 offset:0
  v_mfma_f32_16x16x32_bf16 v[100:103], v[60:63], v[172:175], v[100:103]
  v_mfma_f32_16x16x32_bf16 v[100:103], v[56:59], v[180:183], v[100:103]
  ds_read_b128 v[36:39], v1 offset:16
  v_mfma_f32_16x16x32_bf16 v[100:103], v[52:55], v[188:191], v[100:103]
  v_mfma_f32_16x16x32_bf16 v[96:99], v[52:55], v[184:187], v[96:99]
  ds_read_b128 v[40:43], v1 offset:32
  v_mfma_f32_16x16x32_bf16 v[96:99], v[56:59], v[176:179], v[96:99]
  v_mfma_f32_16x16x32_bf16 v[96:99], v[60:63], v[168:171], v[96:99]
  ds_read_b128 v[44:47], v1 offset:48
  v_mfma_f32_16x16x32_bf16 v[96:99], v[32:35], v[160:163], v[96:99]
  v_mfma_f32_16x16x32_bf16 v[96:99], v[48:51], v[192:195], v[96:99]
  ds_read_b128 v[26:29], v1 offset:64
  v_mfma_f32_16x16x32_bf16 v[96:99], v[76:79], v[200:203], v[96:99]
  v_mfma_f32_16x16x32_bf16 v[96:99], v[72:75], v[208:211], v[96:99]
  ds_read_b128 v[52:55], v1 offset:80
  v_mfma_f32_16x16x32_bf16 v[96:99], v[68:71], v[216:219], v[96:99]
  v_mfma_f32_16x16x32_bf16 v[100:103], v[68:71], v[220:223], v[100:103]
  ds_read_b128 v[56:59], v1 offset:96
  v_mfma_f32_16x16x32_bf16 v[100:103], v[72:75], v[212:215], v[100:103]
  v_mfma_f32_16x16x32_bf16 v[100:103], v[76:79], v[204:207], v[100:103]
  ds_read_b128 v[60:63], v1 offset:112
  v_mfma_f32_16x16x32_bf16 v[100:103], v[48:51], v[196:199], v[100:103]
  s_waitcnt lgkmcnt(10)
  v_mfma_f32_16x16x32_bf16 v[100:103], v[64:67], v[228:231], v[100:103]
  ds_read_b128 v[32:35], v1 offset:128
  v_mfma_f32_16x16x32_bf16 v[100:103], v[22:25], v[236:239], v[100:103]
  s_waitcnt lgkmcnt(9)
  v_mfma_f32_16x16x32_bf16 v[100:103], v[18:21], v[244:247], v[100:103]
  ds_read_b128 v[68:71], v1 offset:144
  v_mfma_f32_16x16x32_bf16 v[100:103], v[84:87], v[252:255], v[100:103]
  v_mfma_f32_16x16x32_bf16 v[96:99], v[84:87], v[248:251], v[96:99]
  ds_read_b128 v[72:75], v1 offset:160
  v_mfma_f32_16x16x32_bf16 v[96:99], v[18:21], v[240:243], v[96:99]
  v_mfma_f32_16x16x32_bf16 v[96:99], v[22:25], v[232:235], v[96:99]
  ds_read_b128 v[76:79], v1 offset:176
  v_mfma_f32_16x16x32_bf16 v[96:99], v[64:67], v[224:227], v[96:99]
  s_nop 7
  ds_write_b128 v7, v[96:99] offset:16384
  ds_write_b128 v7, v[100:103] offset:20480
  s_add_u32 m0, s29, 68112
  s_add_u32 s40, s28, 459000
  buffer_load_dwordx4 v3, s[8:11], s40 offen  lds
  buffer_load_dwordx4 v4, s[96:99], s40 offen offset:1024  lds
  s_add_u32 m0, s29, 70176
  s_add_u32 s40, s28, 461040
  buffer_load_dwordx4 v3, s[8:11], s40 offen  lds
  buffer_load_dwordx4 v4, s[96:99], s40 offen offset:1024  lds
  s_add_u32 m0, s29, 72240
  s_add_u32 s40, s28, 463080
  buffer_load_dwordx4 v3, s[8:11], s40 offen  lds
  buffer_load_dwordx4 v4, s[96:99], s40 offen offset:1024  lds
  s_waitcnt vmcnt(6) lgkmcnt(0)
  s_barrier
  v_mfma_f32_16x16x32_bf16 v[104:107], v[80:83], v[128:131], 0
  ds_read_b128 v[48:51], v1 offset:192
  v_mfma_f32_16x16x32_bf16 v[104:107], v[36:39], v[136:139], v[104:107]
  v_mfma_f32_16x16x32_bf16 v[104:107], v[40:43], v[144:147], v[104:107]
  ds_read_b128 v[84:87], v1 offset:208
  v_mfma_f32_16x16x32_bf16 v[104:107], v[44:47], v[152:155], v[104:107]
  v_mfma_f32_16x16x32_bf16 v[108:111], v[44:47], v[156:159], 0
  ds_read_b128 v[18:21], v1 offset:224
  v_mfma_f32_16x16x32_bf16 v[108:111], v[40:43], v[148:151], v[108:111]
  v_mfma_f32_16x16x32_bf16 v[108:111], v[36:39], v[140:143], v[108:111]
  ds_read_b128 v[22:25], v1 offset:240
  v_mfma_f32_16x16x32_bf16 v[108:111], v[80:83], v[132:135], v[108:111]
  v_mfma_f32_16x16x32_bf16 v[108:111], v[26:29], v[164:167], v[108:111]
  ds_read_b128 v[64:67], v1 offset:33024
  v_mfma_f32_16x16x32_bf16 v[108:111], v[52:55], v[172:175], v[108:111]
  v_mfma_f32_16x16x32_bf16 v[108:111], v[56:59], v[180:183], v[108:111]
  ds_read_b128 v[44:47], v1 offset:33040
  v_mfma_f32_16x16x32_bf16 v[108:111], v[60:63], v[188:191], v[108:111]
  v_mfma_f32_16x16x32_bf16 v[104:107], v[60:63], v[184:187], v[104:107]
  ds_read_b128 v[40:43], v1 offset:33056
  v_mfma_f32_16x16x32_bf16 v[104:107], v[56:59], v[176:179], v[104:107]
  v_mfma_f32_16x16x32_bf16 v[104:107], v[52:55], v[168:171], v[104:107]
  ds_read_b128 v[36:39], v1 offset:33072
  v_mfma_f32_16x16x32_bf16 v[104:107], v[26:29], v[160:163], v[104:107]
  v_mfma_f32_16x16x32_bf16 v[104:107], v[32:35], v[192:195], v[104:107]
  ds_read_b128 v[80:83], v1 offset:33088
  v_mfma_f32_16x16x32_bf16 v[104:107], v[68:71], v[200:203], v[104:107]
  v_mfma_f32_16x16x32_bf16 v[104:107], v[72:75], v[208:211], v[104:107]
  ds_read_b128 v[60:63], v1 offset:33104
  v_mfma_f32_16x16x32_bf16 v[104:107], v[76:79], v[216:219], v[104:107]
  v_mfma_f32_16x16x32_bf16 v[108:111], v[76:79], v[220:223], v[108:111]
  ds_read_b128 v[56:59], v1 offset:33120
  v_mfma_f32_16x16x32_bf16 v[108:111], v[72:75], v[212:215], v[108:111]
  v_mfma_f32_16x16x32_bf16 v[108:111], v[68:71], v[204:207], v[108:111]
  ds_read_b128 v[52:55], v1 offset:33136
  v_mfma_f32_16x16x32_bf16 v[108:111], v[32:35], v[196:199], v[108:111]
  s_waitcnt lgkmcnt(10)
  v_mfma_f32_16x16x32_bf16 v[108:111], v[48:51], v[228:231], v[108:111]
  ds_read_b128 v[26:29], v1 offset:33152
  v_mfma_f32_16x16x32_bf16 v[108:111], v[84:87], v[236:239], v[108:111]
  s_waitcnt lgkmcnt(9)
  v_mfma_f32_16x16x32_bf16 v[108:111], v[18:21], v[244:247], v[108:111]
  ds_read_b128 v[76:79], v1 offset:33168
  v_mfma_f32_16x16x32_bf16 v[108:111], v[22:25], v[252:255], v[108:111]
  v_mfma_f32_16x16x32_bf16 v[104:107], v[22:25], v[248:251], v[104:107]
  ds_read_b128 v[72:75], v1 offset:33184
  v_mfma_f32_16x16x32_bf16 v[104:107], v[18:21], v[240:243], v[104:107]
  v_mfma_f32_16x16x32_bf16 v[104:107], v[84:87], v[232:235], v[104:107]
  ds_read_b128 v[68:71], v1 offset:33200
  v_mfma_f32_16x16x32_bf16 v[104:107], v[48:51], v[224:227], v[104:107]
  s_nop 7
  ds_write_b128 v7, v[104:107] offset:0
  ds_write_b128 v7, v[108:111] offset:4096
  s_waitcnt vmcnt(0) lgkmcnt(0)
  s_barrier
  v_mfma_f32_16x16x32_bf16 v[112:115], v[64:67], v[128:131], 0
  ds_read_b128 v[32:35], v1 offset:33216
  v_mfma_f32_16x16x32_bf16 v[112:115], v[44:47], v[136:139], v[112:115]
  v_mfma_f32_16x16x32_bf16 v[112:115], v[40:43], v[144:147], v[112:115]
  ds_read_b128 v[22:25], v1 offset:33232
  v_mfma_f32_16x16x32_bf16 v[112:115], v[36:39], v[152:155], v[112:115]
  v_mfma_f32_16x16x32_bf16 v[116:119], v[36:39], v[156:159], 0
  ds_read_b128 v[18:21], v1 offset:33248
  v_mfma_f32_16x16x32_bf16 v[116:119], v[40:43], v[148:151], v[116:119]
  v_mfma_f32_16x16x32_bf16 v[116:119], v[44:47], v[140:143], v[116:119]
  ds_read_b128 v[84:87], v1 offset:33264
  v_mfma_f32_16x16x32_bf16 v[116:119], v[64:67], v[132:135], v[116:119]
  v_mfma_f32_16x16x32_bf16 v[116:119], v[80:83], v[164:167], v[116:119]
  ds_read_b128 v[48:51], v2 offset:0
  v_mfma_f32_16x16x32_bf16 v[116:119], v[60:63], v[172:175], v[116:119]
  v_mfma_f32_16x16x32_bf16 v[116:119], v[56:59], v[180:183], v[116:119]
  ds_read_b128 v[36:39], v2 offset:16
  v_mfma_f32_16x16x32_bf16 v[116:119], v[52:55], v[188:191], v[116:119]
  v_mfma_f32_16x16x32_bf16 v[112:115], v[52:55], v[184:187], v[112:115]
  ds_read_b128 v[40:43], v2 offset:32
  v_mfma_f32_16x16x32_bf16 v[112:115], v[56:59], v[176:179], v[112:115]
  v_mfma_f32_16x16x32_bf16 v[112:115], v[60:63], v[168:171], v[112:115]
  ds_read_b128 v[44:47], v2 offset:48
  v_mfma_f32_16x16x32_bf16 v[112:115], v[80:83], v[160:163], v[112:115]
  v_mfma_f32_16x16x32_bf16 v[112:115], v[26:29], v[192:195], v[112:115]
  ds_read_b128 v[64:67], v2 offset:64
  v_mfma_f32_16x16x32_bf16 v[112:115], v[76:79], v[200:203], v[112:115]
  v_mfma_f32_16x16x32_bf16 v[112:115], v[72:75], v[208:211], v[112:115]
  ds_read_b128 v[52:55], v2 offset:80
  v_mfma_f32_16x16x32_bf16 v[112:115], v[68:71], v[216:219], v[112:115]
  v_mfma_f32_16x16x32_bf16 v[116:119], v[68:71], v[220:223], v[116:119]
  ds_read_b128 v[56:59], v2 offset:96
  v_mfma_f32_16x16x32_bf16 v[116:119], v[72:75], v[212:215], v[116:119]
  v_mfma_f32_16x16x32_bf16 v[116:119], v[76:79], v[204:207], v[116:119]
  ds_read_b128 v[60:63], v2 offset:112
  v_mfma_f32_16x16x32_bf16 v[116:119], v[26:29], v[196:199], v[116:119]
  s_waitcnt lgkmcnt(10)
  v_mfma_f32_16x16x32_bf16 v[116:119], v[32:35], v[228:231], v[116:119]
  ds_read_b128 v[80:83], v2 offset:128
  v_mfma_f32_16x16x32_bf16 v[116:119], v[22:25], v[236:239], v[116:119]
  s_waitcnt lgkmcnt(9)
  v_mfma_f32_16x16x32_bf16 v[116:119], v[18:21], v[244:247], v[116:119]
  ds_read_b128 v[68:71], v2 offset:144
  v_mfma_f32_16x16x32_bf16 v[116:119], v[84:87], v[252:255], v[116:119]
  v_mfma_f32_16x16x32_bf16 v[112:115], v[84:87], v[248:251], v[112:115]
  ds_read_b128 v[72:75], v2 offset:160
  v_mfma_f32_16x16x32_bf16 v[112:115], v[18:21], v[240:243], v[112:115]
  v_mfma_f32_16x16x32_bf16 v[112:115], v[22:25], v[232:235], v[112:115]
  ds_read_b128 v[76:79], v2 offset:176
  v_mfma_f32_16x16x32_bf16 v[112:115], v[32:35], v[224:227], v[112:115]
  s_nop 7
  ds_write_b128 v7, v[112:115] offset:8192
  ds_write_b128 v7, v[116:119] offset:12288
  s_waitcnt lgkmcnt(0)
  s_barrier
  v_mfma_f32_16x16x32_bf16 v[120:123], v[48:51], v[128:131], 0
  ds_read_b128 v[26:29], v2 offset:192
  v_mfma_f32_16x16x32_bf16 v[120:123], v[36:39], v[136:139], v[120:123]
  v_mfma_f32_16x16x32_bf16 v[120:123], v[40:43], v[144:147], v[120:123]
  ds_read_b128 v[84:87], v2 offset:208
  v_mfma_f32_16x16x32_bf16 v[120:123], v[44:47], v[152:155], v[120:123]
  v_mfma_f32_16x16x32_bf16 v[124:127], v[44:47], v[156:159], 0
  ds_read_b128 v[18:21], v2 offset:224
  v_mfma_f32_16x16x32_bf16 v[124:127], v[40:43], v[148:151], v[124:127]
  v_mfma_f32_16x16x32_bf16 v[124:127], v[36:39], v[140:143], v[124:127]
  ds_read_b128 v[22:25], v2 offset:240
  v_mfma_f32_16x16x32_bf16 v[124:127], v[48:51], v[132:135], v[124:127]
  v_mfma_f32_16x16x32_bf16 v[124:127], v[64:67], v[164:167], v[124:127]
  v_mfma_f32_16x16x32_bf16 v[124:127], v[52:55], v[172:175], v[124:127]
  v_mfma_f32_16x16x32_bf16 v[124:127], v[56:59], v[180:183], v[124:127]
  v_mfma_f32_16x16x32_bf16 v[124:127], v[60:63], v[188:191], v[124:127]
  v_mfma_f32_16x16x32_bf16 v[120:123], v[60:63], v[184:187], v[120:123]
  v_mfma_f32_16x16x32_bf16 v[120:123], v[56:59], v[176:179], v[120:123]
  v_mfma_f32_16x16x32_bf16 v[120:123], v[52:55], v[168:171], v[120:123]
  v_mfma_f32_16x16x32_bf16 v[120:123], v[64:67], v[160:163], v[120:123]
  v_mfma_f32_16x16x32_bf16 v[120:123], v[80:83], v[192:195], v[120:123]
  v_mfma_f32_16x16x32_bf16 v[120:123], v[68:71], v[200:203], v[120:123]
  v_mfma_f32_16x16x32_bf16 v[120:123], v[72:75], v[208:211], v[120:123]
  v_mfma_f32_16x16x32_bf16 v[120:123], v[76:79], v[216:219], v[120:123]
  v_mfma_f32_16x16x32_bf16 v[124:127], v[76:79], v[220:223], v[124:127]
  v_mfma_f32_16x16x32_bf16 v[124:127], v[72:75], v[212:215], v[124:127]
  v_mfma_f32_16x16x32_bf16 v[124:127], v[68:71], v[204:207], v[124:127]
  v_mfma_f32_16x16x32_bf16 v[124:127], v[80:83], v[196:199], v[124:127]
  s_waitcnt lgkmcnt(3)
  v_mfma_f32_16x16x32_bf16 v[124:127], v[26:29], v[228:231], v[124:127]
  s_waitcnt lgkmcnt(2)
  v_mfma_f32_16x16x32_bf16 v[124:127], v[84:87], v[236:239], v[124:127]
  s_waitcnt lgkmcnt(1)
  v_mfma_f32_16x16x32_bf16 v[124:127], v[18:21], v[244:247], v[124:127]
  s_waitcnt lgkmcnt(0)
  v_mfma_f32_16x16x32_bf16 v[124:127], v[22:25], v[252:255], v[124:127]
  v_mfma_f32_16x16x32_bf16 v[120:123], v[22:25], v[248:251], v[120:123]
  v_mfma_f32_16x16x32_bf16 v[120:123], v[18:21], v[240:243], v[120:123]
  v_mfma_f32_16x16x32_bf16 v[120:123], v[84:87], v[232:235], v[120:123]
  v_mfma_f32_16x16x32_bf16 v[120:123], v[26:29], v[224:227], v[120:123]
  s_nop 7
  ds_write_b128 v7, v[120:123] offset:16384
  ds_write_b128 v7, v[124:127] offset:20480
  s_waitcnt lgkmcnt(0)
  s_barrier
  s_endpgm
L_codeend:
.section .rodata,"a"
.p2align 6
.amdhsa_kernel standalone__weight_only_int_gptq__prompt_kernel
  .amdhsa_next_free_vgpr 256
  .amdhsa_next_free_sgpr 102
  .amdhsa_accum_offset 256
  .amdhsa_group_segment_fixed_size 0
  .amdhsa_kernarg_size 64
  .amdhsa_user_sgpr_count 2
  .amdhsa_user_sgpr_kernarg_segment_ptr 1
  .amdhsa_system_sgpr_workgroup_id_x 1
  .amdhsa_float_denorm_mode_32 3
.end_amdhsa_kernel
```
